```python
import torch

def _softmax(x, axis=-1):
    return torch.softmax(x, dim=axis)
def _gelu(x):
    return torch.nn.functional.gelu(x, approximate="tanh")
def _silu(x):
    return torch.nn.functional.silu(x)
def _sigmoid(x):
    return torch.sigmoid(x)
def _layernorm(x, axis=-1, eps=1e-5):
    m = x.mean(dim=axis, keepdim=True)
    v = x.var(dim=axis, keepdim=True, unbiased=False)
    return (x - m) / torch.sqrt(v + eps)
def _scatter_add(tgt, idx, src, axis=0):
    return tgt.clone().index_add_(axis, idx, src)
def _segment_sum(src, seg, n):
    out = torch.zeros((n,) + src.shape[1:], dtype=src.dtype)
    return out.index_add_(0, seg, src)
def _pad(x, pw):
    flat = tuple(v for pair in reversed(pw) for v in pair)
    return torch.nn.functional.pad(x, flat)

kernel_name = 'gated_mix__softmax_full_mha__dense_activation_silu__prompt'

def setup_inputs():

    _w = (lambda a: (lambda t: t.to(torch.bfloat16) if t.is_floating_point() else t)(torch.as_tensor(a)))
    def _A_setup():
        B, S, D = 1, 2048, 512
        return {
            "x": _w((lambda *s: torch.randn(*s, dtype=torch.bfloat16) * 0.05)(B, S, D)),
            "wqkv": _w((lambda *s: torch.randn(*s, dtype=torch.bfloat16) * 0.8)(D, 3 * D)),
            "wo": _w((lambda *s: torch.randn(*s, dtype=torch.bfloat16) * 0.05)(D, D)),
        }
    _A_in = _A_setup()

    def _B_setup():
        B, S, D, F = 1, 2048, 512, 1792
        return {
            "x": _w((lambda *s: torch.randn(*s, dtype=torch.bfloat16) * 0.05)(B, S, D)),
            "w1": _w((lambda *s: torch.randn(*s, dtype=torch.bfloat16) * 3.2)(D, F) * (D ** -0.5)),
            "w2": _w((lambda *s: torch.randn(*s, dtype=torch.bfloat16) * 0.8)(F, D) * (F ** -0.5)),
        }
    _B_in = _B_setup()

    return {
        "A_x": _A_in["x"],
        "A_wqkv": _A_in["wqkv"],
        "A_wo": _A_in["wo"],
        "B_x": _B_in["x"],
        "B_w1": _B_in["w1"],
        "B_w2": _B_in["w2"],
        "gate_w": _w((lambda *s: torch.randn(*s, dtype=torch.bfloat16) * 0.05)(512) * 16.0),
    }

def reference(A_x, A_wqkv, A_wo, B_x, B_w1, B_w2, gate_w):
    def _A_ref(x, wqkv, wo):
        B, S, D = x.shape
        H = 32; Dh = D // H
        qkv = (lambda x, *d: x.permute(*d))((x @ wqkv).reshape(B, S, 3, H, Dh), 2, 0, 3, 1, 4)
        q, k, v = qkv[0], qkv[1], qkv[2]
        scale = Dh ** -0.5
        scores = torch.einsum("bhqd,bhkd->bhqk", q, k) * scale
        p = _softmax(scores, axis=-1)
        o = torch.einsum("bhqk,bhkd->bhqd", p, v)
        return (lambda x, *d: x.permute(*d))(o, 0, 2, 1, 3).reshape(B, S, D) @ wo

    def _B_ref(x, w1, w2):
        h = torch.einsum("bsd,df->bsf", x, w1)
        h = _silu(h)
        out = torch.einsum("bsf,fd->bsd", h, w2)
        return out

    x = A_x
    g = _sigmoid((x * gate_w).sum(-1, keepdims=True))
    a = _A_ref(x, A_wqkv, A_wo)
    b = _B_ref(x, B_w1, B_w2)
    return g * a + (1 - g) * b
```

```asm
; @launch grid=(256,1,1) block=(512,1,1) lds=163840
.amdgcn_target "amdgcn-amd-amdhsa--gfx950"
.text
.p2align 12
.text
.globl gated_mix__softmax_full_mha__dense_activation_silu__prompt_kernel
.p2align 8
.type gated_mix__softmax_full_mha__dense_activation_silu__prompt_kernel,@function
gated_mix__softmax_full_mha__dense_activation_silu__prompt_kernel:
  s_cmp_ge_u32 s2, 256
  s_cbranch_scc1 L_end

  s_load_dwordx4 s[4:7], s[0:1], 0
  s_load_dwordx2 s[8:9], s[0:1], 16
  s_load_dwordx4 s[44:47], s[0:1], 32
  s_load_dwordx4 s[52:55], s[0:1], 48
  s_load_dwordx4 s[60:63], s[0:1], 64
  v_lshrrev_b32 v1, 6, v0
  v_and_b32 v2, 63, v0
  v_readfirstlane_b32 s12, v1

  s_getpc_b64 s[96:97]

L_pc0:
  s_cmp_ge_u32 s12, 4
  s_cbranch_scc1 L_noiq
  s_lshr_b32 s98, s2, 3
  v_lshrrev_b32 v3, 4, v0
  s_lshl_b32 s98, s98, 11
  v_lshlrev_b32 v3, 7, v3
  s_sub_u32 s96, s96, L_pc0-gated_mix__softmax_full_mha__dense_activation_silu__prompt_kernel
  s_subb_u32 s97, s97, 0
  v_add_u32 v3, s98, v3
  v_min_u32 v3, L_codeend-gated_mix__softmax_full_mha__dense_activation_silu__prompt_kernel-4, v3
  global_load_dword v127, v3, s[96:97]

L_noiq:
  s_and_b32 s15, s2, 7
  s_lshr_b32 s16, s2, 3
  s_and_b32 s13, s15, 1
  s_lshl_b32 s13, s13, 3
  s_and_b32 s17, s16, 7
  s_add_u32 s13, s13, s17
  s_lshr_b32 s14, s15, 1
  s_lshl_b32 s14, s14, 2
  s_lshr_b32 s17, s16, 3
  s_add_u32 s14, s14, s17
  s_and_b32 s51, s14, 1
  s_lshr_b32 s59, s14, 1

  s_lshr_b32 s3, s14, 3
  s_lshl_b32 s19, s14, 2
  s_add_u32 s50, s19, 2
  s_bfe_u32 s15, s14, 0x10002
  s_mul_i32 s15, s15, 12
  s_add_u32 s15, s15, 32
  s_and_b32 s16, s14, 3
  s_add_u32 s17, s15, s16
  s_add_u32 s15, s17, s16
  s_add_u32 s17, s17, 8
  s_cmp_lg_u32 s3, 0
  s_cselect_b32 s19, s15, s19
  s_cselect_b32 s50, s17, s50
  s_lshl_b32 s100, s13, 3
  s_and_b32 s15, s14, 7
  s_add_u32 s100, s100, s15

  s_mov_b32 s22, 2097152
  s_mov_b32 s23, 0x00020000
  s_mov_b32 s26, 1572864
  s_mov_b32 s27, 0x00020000
  s_mov_b32 s30, 1835008
  s_mov_b32 s31, 0x00020000
  s_mov_b32 s34, 33554432
  s_mov_b32 s35, 0x00020000
  s_mov_b32 s39, 0x00020000
  s_mov_b32 s42, 1024
  s_mov_b32 s43, 0x00020000
  s_mov_b32 s66, 256
  s_mov_b32 s67, 0x00020000
  s_mov_b32 s70, 2097152
  s_mov_b32 s71, 0x00020000
  s_cmp_lt_u32 s12, 4
  s_cbranch_scc1 L_comp

  v_lshrrev_b32 v10, 3, v2
  v_and_b32 v11, 7, v2
  v_lshrrev_b32 v12, 4, v2
  v_xor_b32 v13, v11, v12
  v_lshlrev_b32 v13, 4, v13
  v_lshl_add_u32 v4, v10, 10, v13
  v_xor_b32 v5, 64, v4
  v_and_b32 v12, 1, v12
  v_lshlrev_b32 v12, 2, v12
  v_xor_b32 v13, v11, v12
  v_lshlrev_b32 v13, 4, v13
  v_mul_u32_u24 v6, 3072, v10
  v_add_u32 v6, v6, v13
  v_mul_u32_u24 v8, 3584, v10
  v_add_u32 v8, v8, v13
  v_lshrrev_b32 v10, 2, v2
  v_and_b32 v11, 3, v2
  v_lshlrev_b32 v11, 4, v11
  v_mul_u32_u24 v7, 3072, v10
  v_add_u32 v7, v7, v11
  v_mul_u32_u24 v9, 3584, v10
  v_add_u32 v9, v9, v11
  v_lshlrev_b32 v10, 4, v2
  s_sub_u32 s57, s12, 4
  s_lshl_b32 s96, s57, 12
  s_lshl_b32 s97, s57, 11
  s_lshl_b32 s98, s57, 10
  s_lshl_b32 s99, s57, 13
  s_lshl_b32 s58, s13, 17
  s_lshl_b32 s15, s57, 15
  s_add_u32 s58, s58, s15
  s_lshl_b32 s56, s59, 7
  s_mul_i32 s15, s57, 49152
  s_add_u32 s56, s56, s15
  s_lshl_b32 s16, s51, 10
  s_add_u32 s56, s56, s16
  s_lshl_b32 s57, s14, 6
  s_add_u32 s57, s57, 2048
  s_add_u32 s57, s57, s15

  s_lshr_b32 s17, s14, 2
  s_lshl_b32 s17, s17, 1
  s_add_u32 s17, s17, s13

  s_waitcnt lgkmcnt(0)
  s_mov_b32 s20, s4
  s_mov_b32 s21, s5
  s_mov_b32 s24, s6
  s_mov_b32 s25, s7
  s_mov_b32 s28, s44
  s_mov_b32 s29, s45
  s_mov_b32 s32, s62
  s_mov_b32 s33, s63
  s_mov_b32 s40, s52
  s_mov_b32 s41, s53
  s_mov_b32 s64, s60
  s_mov_b32 s65, s61
  s_mov_b32 s68, s54
  s_mov_b32 s69, s55

  s_sub_u32 s52, s12, 4
  s_mov_b32 s55, s58
  s_and_b32 s63, s17, 7

  s_add_u32 s15, s63, 0
  s_and_b32 s15, s15, 7
  s_lshl_b32 s60, s15, 7
  s_add_u32 s60, s60, s55
  s_mul_i32 s15, s15, 196608
  s_add_u32 s61, s56, s15
  s_add_u32 s62, s57, s15

  s_add_u32 s53, s96, 0
  s_mov_b32 m0, s53
  s_add_u32 s54, s60, 0
  buffer_load_dwordx4 v4, s[20:23], s54 offen lds
  s_add_u32 s53, s96, 1024
  s_mov_b32 m0, s53
  s_add_u32 s54, s60, 8192
  buffer_load_dwordx4 v5, s[20:23], s54 offen lds
  s_add_u32 s53, s96, 2048
  s_mov_b32 m0, s53
  s_add_u32 s54, s60, 16384
  buffer_load_dwordx4 v4, s[20:23], s54 offen lds
  s_add_u32 s53, s96, 3072
  s_mov_b32 m0, s53
  s_add_u32 s54, s60, 24576
  buffer_load_dwordx4 v5, s[20:23], s54 offen lds
  s_add_u32 s53, s97, 16384
  s_mov_b32 m0, s53
  s_add_u32 s54, s61, 0
  buffer_load_dwordx4 v6, s[24:27], s54 offen lds
  s_add_u32 s53, s97, 17408
  s_mov_b32 m0, s53
  s_add_u32 s54, s61, 24576
  buffer_load_dwordx4 v6, s[24:27], s54 offen lds
  s_add_u32 s53, s98, 24576
  s_mov_b32 m0, s53
  s_add_u32 s54, s62, 0
  buffer_load_dwordx4 v7, s[24:27], s54 offen lds
  s_lshl_b32 s15, s52, 8
  s_add_u32 s53, s15, 94208
  s_mov_b32 m0, s53
  s_mov_b64 exec, 0xffff
  buffer_load_dwordx4 v10, s[40:43], s15 offen lds
  s_mov_b64 exec, -1

  s_add_u32 s15, s63, 1
  s_and_b32 s15, s15, 7
  s_lshl_b32 s60, s15, 7
  s_add_u32 s60, s60, s55
  s_mul_i32 s15, s15, 196608
  s_add_u32 s61, s56, s15
  s_add_u32 s62, s57, s15

  s_add_u32 s53, s96, 32768
  s_mov_b32 m0, s53
  s_add_u32 s54, s60, 0
  buffer_load_dwordx4 v4, s[20:23], s54 offen lds
  s_add_u32 s53, s96, 33792
  s_mov_b32 m0, s53
  s_add_u32 s54, s60, 8192
  buffer_load_dwordx4 v5, s[20:23], s54 offen lds
  s_add_u32 s53, s96, 34816
  s_mov_b32 m0, s53
  s_add_u32 s54, s60, 16384
  buffer_load_dwordx4 v4, s[20:23], s54 offen lds
  s_add_u32 s53, s96, 35840
  s_mov_b32 m0, s53
  s_add_u32 s54, s60, 24576
  buffer_load_dwordx4 v5, s[20:23], s54 offen lds
  s_add_u32 s53, s97, 49152
  s_mov_b32 m0, s53
  s_add_u32 s54, s61, 0
  buffer_load_dwordx4 v6, s[24:27], s54 offen lds
  s_add_u32 s53, s97, 50176
  s_mov_b32 m0, s53
  s_add_u32 s54, s61, 24576
  buffer_load_dwordx4 v6, s[24:27], s54 offen lds
  s_add_u32 s53, s98, 57344
  s_mov_b32 m0, s53
  s_add_u32 s54, s62, 0
  buffer_load_dwordx4 v7, s[24:27], s54 offen lds
  s_cmp_lg_u32 s2, 0
  s_cbranch_scc1 L_notok
  s_cmp_lg_u32 s12, 4
  s_cbranch_scc1 L_notok
  s_memrealtime s[72:73]
  v_mov_b32 v54, 0
  s_waitcnt lgkmcnt(0)
  s_or_b32 s72, s72, 1
  v_mov_b32 v52, s72
  v_mov_b32 v53, s73
  s_mov_b64 exec, 1
  buffer_store_dwordx2 v[52:53], v54, s[64:67], 0 offen sc1
  s_mov_b64 exec, -1
  s_waitcnt vmcnt(0)

L_notok:
  v_lshrrev_b32 v20, 4, v2
  v_lshlrev_b32 v20, 10, v20
  v_and_b32 v21, 15, v2
  v_lshl_add_u32 v16, v21, 4, v20
  v_lshrrev_b32 v20, 5, v2
  v_lshlrev_b32 v20, 10, v20
  v_bfe_u32 v21, v2, 2, 2
  v_lshl_add_u32 v20, v21, 8, v20
  v_bfe_u32 v21, v2, 4, 1
  v_lshl_add_u32 v20, v21, 5, v20
  v_and_b32 v21, 3, v2
  v_lshl_add_u32 v17, v21, 3, v20
  s_add_u32 s15, s96, 32768
  v_add_u32 v17, s15, v17

  v_and_b32 v20, 31, v2
  v_lshlrev_b32 v20, 7, v20
  v_add_u32 v20, s96, v20
  v_lshrrev_b32 v21, 5, v2
  v_bfe_u32 v22, v2, 1, 3
  v_lshlrev_b32 v55, 4, v21
  v_add_u32 v55, 94208, v55

  v_or_b32 v23, 0, v21
  v_xor_b32 v23, v23, v22
  v_lshl_add_u32 v56, v23, 4, v20
  v_or_b32 v23, 2, v21
  v_xor_b32 v23, v23, v22
  v_lshl_add_u32 v57, v23, 4, v20
  v_or_b32 v23, 4, v21
  v_xor_b32 v23, v23, v22
  v_lshl_add_u32 v58, v23, 4, v20
  v_or_b32 v23, 6, v21
  v_xor_b32 v23, v23, v22
  v_lshl_add_u32 v59, v23, 4, v20
  s_waitcnt vmcnt(7)
  s_barrier
  s_add_u32 s15, s63, 2
  s_and_b32 s15, s15, 7
  s_lshl_b32 s60, s15, 7
  s_add_u32 s60, s60, s55
  s_mul_i32 s15, s15, 196608
  s_add_u32 s61, s56, s15
  s_add_u32 s62, s57, s15

  s_add_u32 s53, s96, 65536
  s_mov_b32 m0, s53
  s_add_u32 s54, s60, 0
  buffer_load_dwordx4 v4, s[20:23], s54 offen lds
  s_add_u32 s53, s96, 66560
  s_mov_b32 m0, s53
  s_add_u32 s54, s60, 8192
  buffer_load_dwordx4 v5, s[20:23], s54 offen lds
  s_add_u32 s53, s96, 67584
  s_mov_b32 m0, s53
  s_add_u32 s54, s60, 16384
  buffer_load_dwordx4 v4, s[20:23], s54 offen lds
  s_add_u32 s53, s96, 68608
  s_mov_b32 m0, s53
  s_add_u32 s54, s60, 24576
  buffer_load_dwordx4 v5, s[20:23], s54 offen lds
  s_add_u32 s53, s97, 81920
  s_mov_b32 m0, s53
  s_add_u32 s54, s61, 0
  buffer_load_dwordx4 v6, s[24:27], s54 offen lds
  s_add_u32 s53, s97, 82944
  s_mov_b32 m0, s53
  s_add_u32 s54, s61, 24576
  buffer_load_dwordx4 v6, s[24:27], s54 offen lds
  s_add_u32 s53, s98, 90112
  s_mov_b32 m0, s53
  s_add_u32 s54, s62, 0
  buffer_load_dwordx4 v7, s[24:27], s54 offen lds
  s_add_u32 s15, s63, 3
  s_and_b32 s15, s15, 7
  s_lshl_b32 s60, s15, 7
  s_add_u32 s60, s60, s55
  s_mul_i32 s15, s15, 196608
  s_add_u32 s61, s56, s15
  s_add_u32 s62, s57, s15

  s_add_u32 s53, s96, 98304
  s_mov_b32 m0, s53
  s_add_u32 s54, s60, 0
  buffer_load_dwordx4 v4, s[20:23], s54 offen lds
  s_add_u32 s53, s96, 99328
  s_mov_b32 m0, s53
  s_add_u32 s54, s60, 8192
  buffer_load_dwordx4 v5, s[20:23], s54 offen lds
  s_add_u32 s53, s96, 100352
  s_mov_b32 m0, s53
  s_add_u32 s54, s60, 16384
  buffer_load_dwordx4 v4, s[20:23], s54 offen lds
  s_add_u32 s53, s96, 101376
  s_mov_b32 m0, s53
  s_add_u32 s54, s60, 24576
  buffer_load_dwordx4 v5, s[20:23], s54 offen lds
  s_add_u32 s53, s97, 114688
  s_mov_b32 m0, s53
  s_add_u32 s54, s61, 0
  buffer_load_dwordx4 v6, s[24:27], s54 offen lds
  s_add_u32 s53, s97, 115712
  s_mov_b32 m0, s53
  s_add_u32 s54, s61, 24576
  buffer_load_dwordx4 v6, s[24:27], s54 offen lds
  s_add_u32 s53, s98, 122880
  s_mov_b32 m0, s53
  s_add_u32 s54, s62, 0
  buffer_load_dwordx4 v7, s[24:27], s54 offen lds
  s_cmp_lg_u32 s14, 1
  s_cbranch_scc1 L_ng1
  s_add_u32 s15, s63, 0
  s_and_b32 s15, s15, 7
  s_lshl_b32 s15, s15, 7
  v_add_u32 v20, s15, v55
  v_add_u32 v21, 0, v56
  ds_read_b128 v[60:63], v21
  ds_read_b128 v[76:79], v20 offset:0
  v_add_u32 v21, 0, v57
  ds_read_b128 v[64:67], v21
  ds_read_b128 v[80:83], v20 offset:32
  v_add_u32 v21, 0, v58
  ds_read_b128 v[68:71], v21
  ds_read_b128 v[84:87], v20 offset:64
  v_add_u32 v21, 0, v59
  ds_read_b128 v[72:75], v21
  ds_read_b128 v[88:91], v20 offset:96
  s_waitcnt lgkmcnt(6)
  v_mfma_f32_32x32x16_bf16 v[92:107], v[76:79], v[60:63], 0
  s_waitcnt lgkmcnt(4)
  v_mfma_f32_32x32x16_bf16 v[92:107], v[80:83], v[64:67], v[92:107]
  s_waitcnt lgkmcnt(2)
  v_mfma_f32_32x32x16_bf16 v[92:107], v[84:87], v[68:71], v[92:107]
  s_waitcnt lgkmcnt(0)
  v_mfma_f32_32x32x16_bf16 v[92:107], v[88:91], v[72:75], v[92:107]
L_ng1:
  s_waitcnt vmcnt(14)
  s_barrier
  s_add_u32 s15, s63, 4
  s_and_b32 s15, s15, 7
  s_lshl_b32 s60, s15, 7
  s_add_u32 s60, s60, s55
  s_mul_i32 s15, s15, 196608
  s_add_u32 s61, s56, s15
  s_add_u32 s62, s57, s15

  s_add_u32 s53, s96, 131072
  s_mov_b32 m0, s53
  s_add_u32 s54, s60, 0
  buffer_load_dwordx4 v4, s[20:23], s54 offen lds
  s_add_u32 s53, s96, 132096
  s_mov_b32 m0, s53
  s_add_u32 s54, s60, 8192
  buffer_load_dwordx4 v5, s[20:23], s54 offen lds
  s_add_u32 s53, s96, 133120
  s_mov_b32 m0, s53
  s_add_u32 s54, s60, 16384
  buffer_load_dwordx4 v4, s[20:23], s54 offen lds
  s_add_u32 s53, s96, 134144
  s_mov_b32 m0, s53
  s_add_u32 s54, s60, 24576
  buffer_load_dwordx4 v5, s[20:23], s54 offen lds
  s_add_u32 s53, s97, 147456
  s_mov_b32 m0, s53
  s_add_u32 s54, s61, 0
  buffer_load_dwordx4 v6, s[24:27], s54 offen lds
  s_add_u32 s53, s97, 148480
  s_mov_b32 m0, s53
  s_add_u32 s54, s61, 24576
  buffer_load_dwordx4 v6, s[24:27], s54 offen lds
  s_add_u32 s53, s98, 155648
  s_mov_b32 m0, s53
  s_add_u32 s54, s62, 0
  buffer_load_dwordx4 v7, s[24:27], s54 offen lds
  s_cmp_lg_u32 s14, 1
  s_cbranch_scc1 L_ng2
  s_add_u32 s15, s63, 1
  s_and_b32 s15, s15, 7
  s_lshl_b32 s15, s15, 7
  v_add_u32 v20, s15, v55
  v_add_u32 v21, 32768, v56
  ds_read_b128 v[60:63], v21
  ds_read_b128 v[76:79], v20 offset:0
  v_add_u32 v21, 32768, v57
  ds_read_b128 v[64:67], v21
  ds_read_b128 v[80:83], v20 offset:32
  v_add_u32 v21, 32768, v58
  ds_read_b128 v[68:71], v21
  ds_read_b128 v[84:87], v20 offset:64
  v_add_u32 v21, 32768, v59
  ds_read_b128 v[72:75], v21
  ds_read_b128 v[88:91], v20 offset:96
  s_waitcnt lgkmcnt(6)
  v_mfma_f32_32x32x16_bf16 v[92:107], v[76:79], v[60:63], v[92:107]
  s_waitcnt lgkmcnt(4)
  v_mfma_f32_32x32x16_bf16 v[92:107], v[80:83], v[64:67], v[92:107]
  s_waitcnt lgkmcnt(2)
  v_mfma_f32_32x32x16_bf16 v[92:107], v[84:87], v[68:71], v[92:107]
  s_waitcnt lgkmcnt(0)
  v_mfma_f32_32x32x16_bf16 v[92:107], v[88:91], v[72:75], v[92:107]
L_ng2:
  s_waitcnt vmcnt(14)
  s_barrier
  s_add_u32 s15, s63, 5
  s_and_b32 s15, s15, 7
  s_lshl_b32 s60, s15, 7
  s_add_u32 s60, s60, s55
  s_mul_i32 s15, s15, 196608
  s_add_u32 s61, s56, s15
  s_add_u32 s62, s57, s15

  s_add_u32 s53, s96, 0
  s_mov_b32 m0, s53
  s_add_u32 s54, s60, 0
  buffer_load_dwordx4 v4, s[20:23], s54 offen lds
  s_add_u32 s53, s96, 1024
  s_mov_b32 m0, s53
  s_add_u32 s54, s60, 8192
  buffer_load_dwordx4 v5, s[20:23], s54 offen lds
  s_add_u32 s53, s96, 2048
  s_mov_b32 m0, s53
  s_add_u32 s54, s60, 16384
  buffer_load_dwordx4 v4, s[20:23], s54 offen lds
  s_add_u32 s53, s96, 3072
  s_mov_b32 m0, s53
  s_add_u32 s54, s60, 24576
  buffer_load_dwordx4 v5, s[20:23], s54 offen lds
  s_add_u32 s53, s97, 16384
  s_mov_b32 m0, s53
  s_add_u32 s54, s61, 0
  buffer_load_dwordx4 v6, s[24:27], s54 offen lds
  s_add_u32 s53, s97, 17408
  s_mov_b32 m0, s53
  s_add_u32 s54, s61, 24576
  buffer_load_dwordx4 v6, s[24:27], s54 offen lds
  s_add_u32 s53, s98, 24576
  s_mov_b32 m0, s53
  s_add_u32 s54, s62, 0
  buffer_load_dwordx4 v7, s[24:27], s54 offen lds
  s_cmp_lg_u32 s14, 1
  s_cbranch_scc1 L_ng3
  s_add_u32 s15, s63, 2
  s_and_b32 s15, s15, 7
  s_lshl_b32 s15, s15, 7
  v_add_u32 v20, s15, v55
  v_add_u32 v21, 65536, v56
  ds_read_b128 v[60:63], v21
  ds_read_b128 v[76:79], v20 offset:0
  v_add_u32 v21, 65536, v57
  ds_read_b128 v[64:67], v21
  ds_read_b128 v[80:83], v20 offset:32
  v_add_u32 v21, 65536, v58
  ds_read_b128 v[68:71], v21
  ds_read_b128 v[84:87], v20 offset:64
  v_add_u32 v21, 65536, v59
  ds_read_b128 v[72:75], v21
  ds_read_b128 v[88:91], v20 offset:96
  s_waitcnt lgkmcnt(6)
  v_mfma_f32_32x32x16_bf16 v[92:107], v[76:79], v[60:63], v[92:107]
  s_waitcnt lgkmcnt(4)
  v_mfma_f32_32x32x16_bf16 v[92:107], v[80:83], v[64:67], v[92:107]
  s_waitcnt lgkmcnt(2)
  v_mfma_f32_32x32x16_bf16 v[92:107], v[84:87], v[68:71], v[92:107]
  s_waitcnt lgkmcnt(0)
  v_mfma_f32_32x32x16_bf16 v[92:107], v[88:91], v[72:75], v[92:107]
L_ng3:
  s_waitcnt vmcnt(14)
  s_barrier
  s_add_u32 s15, s63, 6
  s_and_b32 s15, s15, 7
  s_lshl_b32 s60, s15, 7
  s_add_u32 s60, s60, s55
  s_mul_i32 s15, s15, 196608
  s_add_u32 s61, s56, s15
  s_add_u32 s62, s57, s15

  s_add_u32 s53, s96, 32768
  s_mov_b32 m0, s53
  s_add_u32 s54, s60, 0
  buffer_load_dwordx4 v4, s[20:23], s54 offen lds
  s_add_u32 s53, s96, 33792
  s_mov_b32 m0, s53
  s_add_u32 s54, s60, 8192
  buffer_load_dwordx4 v5, s[20:23], s54 offen lds
  s_add_u32 s53, s96, 34816
  s_mov_b32 m0, s53
  s_add_u32 s54, s60, 16384
  buffer_load_dwordx4 v4, s[20:23], s54 offen lds
  s_add_u32 s53, s96, 35840
  s_mov_b32 m0, s53
  s_add_u32 s54, s60, 24576
  buffer_load_dwordx4 v5, s[20:23], s54 offen lds
  s_add_u32 s53, s97, 49152
  s_mov_b32 m0, s53
  s_add_u32 s54, s61, 0
  buffer_load_dwordx4 v6, s[24:27], s54 offen lds
  s_add_u32 s53, s97, 50176
  s_mov_b32 m0, s53
  s_add_u32 s54, s61, 24576
  buffer_load_dwordx4 v6, s[24:27], s54 offen lds
  s_add_u32 s53, s98, 57344
  s_mov_b32 m0, s53
  s_add_u32 s54, s62, 0
  buffer_load_dwordx4 v7, s[24:27], s54 offen lds
  s_cmp_lg_u32 s14, 1
  s_cbranch_scc1 L_ng4
  s_add_u32 s15, s63, 3
  s_and_b32 s15, s15, 7
  s_lshl_b32 s15, s15, 7
  v_add_u32 v20, s15, v55
  v_add_u32 v21, 98304, v56
  ds_read_b128 v[60:63], v21
  ds_read_b128 v[76:79], v20 offset:0
  v_add_u32 v21, 98304, v57
  ds_read_b128 v[64:67], v21
  ds_read_b128 v[80:83], v20 offset:32
  v_add_u32 v21, 98304, v58
  ds_read_b128 v[68:71], v21
  ds_read_b128 v[84:87], v20 offset:64
  v_add_u32 v21, 98304, v59
  ds_read_b128 v[72:75], v21
  ds_read_b128 v[88:91], v20 offset:96
  s_waitcnt lgkmcnt(6)
  v_mfma_f32_32x32x16_bf16 v[92:107], v[76:79], v[60:63], v[92:107]
  s_waitcnt lgkmcnt(4)
  v_mfma_f32_32x32x16_bf16 v[92:107], v[80:83], v[64:67], v[92:107]
  s_waitcnt lgkmcnt(2)
  v_mfma_f32_32x32x16_bf16 v[92:107], v[84:87], v[68:71], v[92:107]
  s_waitcnt lgkmcnt(0)
  v_mfma_f32_32x32x16_bf16 v[92:107], v[88:91], v[72:75], v[92:107]
L_ng4:
  s_waitcnt vmcnt(14)
  s_barrier
  s_add_u32 s15, s63, 7
  s_and_b32 s15, s15, 7
  s_lshl_b32 s60, s15, 7
  s_add_u32 s60, s60, s55
  s_mul_i32 s15, s15, 196608
  s_add_u32 s61, s56, s15
  s_add_u32 s62, s57, s15

  s_add_u32 s53, s96, 65536
  s_mov_b32 m0, s53
  s_add_u32 s54, s60, 0
  buffer_load_dwordx4 v4, s[20:23], s54 offen lds
  s_add_u32 s53, s96, 66560
  s_mov_b32 m0, s53
  s_add_u32 s54, s60, 8192
  buffer_load_dwordx4 v5, s[20:23], s54 offen lds
  s_add_u32 s53, s96, 67584
  s_mov_b32 m0, s53
  s_add_u32 s54, s60, 16384
  buffer_load_dwordx4 v4, s[20:23], s54 offen lds
  s_add_u32 s53, s96, 68608
  s_mov_b32 m0, s53
  s_add_u32 s54, s60, 24576
  buffer_load_dwordx4 v5, s[20:23], s54 offen lds
  s_add_u32 s53, s97, 81920
  s_mov_b32 m0, s53
  s_add_u32 s54, s61, 0
  buffer_load_dwordx4 v6, s[24:27], s54 offen lds
  s_add_u32 s53, s97, 82944
  s_mov_b32 m0, s53
  s_add_u32 s54, s61, 24576
  buffer_load_dwordx4 v6, s[24:27], s54 offen lds
  s_add_u32 s53, s98, 90112
  s_mov_b32 m0, s53
  s_add_u32 s54, s62, 0
  buffer_load_dwordx4 v7, s[24:27], s54 offen lds
  s_and_b32 s15, s13, 7
  s_lshl_b32 s15, s15, 2
  s_add_u32 s15, s15, s52
  s_mul_i32 s15, s15, 57344
  s_lshl_b32 s16, s50, 6
  s_add_u32 s15, s15, s16
  v_mul_u32_u24 v20, 3584, v2
  s_mov_b64 exec, 0xffff
  buffer_load_dword v24, v20, s[28:31], s15 offen
  s_mov_b64 exec, -1

  s_and_b32 s15, s13, 7
  s_lshl_b32 s15, s15, 2
  s_add_u32 s15, s15, s52
  s_mul_i32 s15, s15, 57344
  s_lshl_b32 s16, s19, 6
  s_add_u32 s15, s15, s16
  v_mul_u32_u24 v20, 3584, v2
  s_mov_b64 exec, 0xffff
  buffer_load_dword v27, v20, s[28:31], s15 offen
  s_mov_b64 exec, -1

  s_cmp_lg_u32 s14, 1
  s_cbranch_scc1 L_ng5
  s_add_u32 s15, s63, 4
  s_and_b32 s15, s15, 7
  s_lshl_b32 s15, s15, 7
  v_add_u32 v20, s15, v55
  v_add_u32 v21, 131072, v56
  ds_read_b128 v[60:63], v21
  ds_read_b128 v[76:79], v20 offset:0
  v_add_u32 v21, 131072, v57
  ds_read_b128 v[64:67], v21
  ds_read_b128 v[80:83], v20 offset:32
  v_add_u32 v21, 131072, v58
  ds_read_b128 v[68:71], v21
  ds_read_b128 v[84:87], v20 offset:64
  v_add_u32 v21, 131072, v59
  ds_read_b128 v[72:75], v21
  ds_read_b128 v[88:91], v20 offset:96
  s_waitcnt lgkmcnt(6)
  v_mfma_f32_32x32x16_bf16 v[92:107], v[76:79], v[60:63], v[92:107]
  s_waitcnt lgkmcnt(4)
  v_mfma_f32_32x32x16_bf16 v[92:107], v[80:83], v[64:67], v[92:107]
  s_waitcnt lgkmcnt(2)
  v_mfma_f32_32x32x16_bf16 v[92:107], v[84:87], v[68:71], v[92:107]
  s_waitcnt lgkmcnt(0)
  v_mfma_f32_32x32x16_bf16 v[92:107], v[88:91], v[72:75], v[92:107]
L_ng5:
  s_waitcnt vmcnt(16)
  s_barrier
  v_mov_b32 v54, 0
  buffer_load_dwordx2 v[52:53], v54, s[64:67], 0 offen sc1
  s_cmp_lg_u32 s14, 1
  s_cbranch_scc1 L_ng6
  s_add_u32 s15, s63, 5
  s_and_b32 s15, s15, 7
  s_lshl_b32 s15, s15, 7
  v_add_u32 v20, s15, v55
  v_add_u32 v21, 0, v56
  ds_read_b128 v[60:63], v21
  ds_read_b128 v[76:79], v20 offset:0
  v_add_u32 v21, 0, v57
  ds_read_b128 v[64:67], v21
  ds_read_b128 v[80:83], v20 offset:32
  v_add_u32 v21, 0, v58
  ds_read_b128 v[68:71], v21
  ds_read_b128 v[84:87], v20 offset:64
  v_add_u32 v21, 0, v59
  ds_read_b128 v[72:75], v21
  ds_read_b128 v[88:91], v20 offset:96
  s_waitcnt lgkmcnt(6)
  v_mfma_f32_32x32x16_bf16 v[92:107], v[76:79], v[60:63], v[92:107]
  s_waitcnt lgkmcnt(4)
  v_mfma_f32_32x32x16_bf16 v[92:107], v[80:83], v[64:67], v[92:107]
  s_waitcnt lgkmcnt(2)
  v_mfma_f32_32x32x16_bf16 v[92:107], v[84:87], v[68:71], v[92:107]
  s_waitcnt lgkmcnt(0)
  v_mfma_f32_32x32x16_bf16 v[92:107], v[88:91], v[72:75], v[92:107]
L_ng6:
  s_waitcnt vmcnt(10)
  s_barrier
  s_lshl_b32 s58, s19, 6
  s_add_u32 s15, s52, s63
  s_add_u32 s15, s15, 0
  s_and_b32 s15, s15, 7
  s_mul_i32 s15, s15, 229376
  s_add_u32 s58, s58, s15
  s_add_u32 s53, s99, 98304
  s_mov_b32 m0, s53
  s_add_u32 s54, s58, 0
  buffer_load_dwordx4 v8, s[28:31], s54 offen lds
  s_add_u32 s53, s99, 99328
  s_mov_b32 m0, s53
  s_add_u32 s54, s58, 28672
  buffer_load_dwordx4 v8, s[28:31], s54 offen lds
  s_add_u32 s53, s99, 100352
  s_mov_b32 m0, s53
  s_add_u32 s54, s58, 57344
  buffer_load_dwordx4 v8, s[28:31], s54 offen lds
  s_add_u32 s53, s99, 101376
  s_mov_b32 m0, s53
  s_add_u32 s54, s58, 86016
  buffer_load_dwordx4 v8, s[28:31], s54 offen lds
  s_add_u32 s53, s99, 102400
  s_mov_b32 m0, s53
  s_add_u32 s54, s58, 114688
  buffer_load_dwordx4 v8, s[28:31], s54 offen lds
  s_add_u32 s53, s99, 103424
  s_mov_b32 m0, s53
  s_add_u32 s54, s58, 143360
  buffer_load_dwordx4 v8, s[28:31], s54 offen lds
  s_add_u32 s53, s99, 104448
  s_mov_b32 m0, s53
  s_add_u32 s54, s58, 172032
  buffer_load_dwordx4 v8, s[28:31], s54 offen lds
  s_add_u32 s53, s99, 105472
  s_mov_b32 m0, s53
  s_add_u32 s54, s58, 200704
  buffer_load_dwordx4 v8, s[28:31], s54 offen lds
  s_cmp_lg_u32 s14, 1
  s_cbranch_scc1 L_ng7
  s_add_u32 s15, s63, 6
  s_and_b32 s15, s15, 7
  s_lshl_b32 s15, s15, 7
  v_add_u32 v20, s15, v55
  v_add_u32 v21, 32768, v56
  ds_read_b128 v[60:63], v21
  ds_read_b128 v[76:79], v20 offset:0
  v_add_u32 v21, 32768, v57
  ds_read_b128 v[64:67], v21
  ds_read_b128 v[80:83], v20 offset:32
  v_add_u32 v21, 32768, v58
  ds_read_b128 v[68:71], v21
  ds_read_b128 v[84:87], v20 offset:64
  v_add_u32 v21, 32768, v59
  ds_read_b128 v[72:75], v21
  ds_read_b128 v[88:91], v20 offset:96
  s_waitcnt lgkmcnt(6)
  v_mfma_f32_32x32x16_bf16 v[92:107], v[76:79], v[60:63], v[92:107]
  s_waitcnt lgkmcnt(4)
  v_mfma_f32_32x32x16_bf16 v[92:107], v[80:83], v[64:67], v[92:107]
  s_waitcnt lgkmcnt(2)
  v_mfma_f32_32x32x16_bf16 v[92:107], v[84:87], v[68:71], v[92:107]
  s_waitcnt lgkmcnt(0)
  v_mfma_f32_32x32x16_bf16 v[92:107], v[88:91], v[72:75], v[92:107]
L_ng7:
  s_cmp_lg_u32 s3, 0
  s_cbranch_scc1 L_lodd
  s_waitcnt vmcnt(11)
  s_barrier
  s_lshl_b32 s58, s19, 6
  s_add_u32 s15, s52, s63
  s_add_u32 s15, s15, 4
  s_and_b32 s15, s15, 7
  s_mul_i32 s15, s15, 229376
  s_add_u32 s58, s58, s15
  s_add_u32 s53, s99, 131072
  s_mov_b32 m0, s53
  s_add_u32 s54, s58, 0
  buffer_load_dwordx4 v8, s[28:31], s54 offen lds
  s_add_u32 s53, s99, 132096
  s_mov_b32 m0, s53
  s_add_u32 s54, s58, 28672
  buffer_load_dwordx4 v8, s[28:31], s54 offen lds
  s_add_u32 s53, s99, 133120
  s_mov_b32 m0, s53
  s_add_u32 s54, s58, 57344
  buffer_load_dwordx4 v8, s[28:31], s54 offen lds
  s_add_u32 s53, s99, 134144
  s_mov_b32 m0, s53
  s_add_u32 s54, s58, 86016
  buffer_load_dwordx4 v8, s[28:31], s54 offen lds
  s_add_u32 s53, s99, 135168
  s_mov_b32 m0, s53
  s_add_u32 s54, s58, 114688
  buffer_load_dwordx4 v8, s[28:31], s54 offen lds
  s_add_u32 s53, s99, 136192
  s_mov_b32 m0, s53
  s_add_u32 s54, s58, 143360
  buffer_load_dwordx4 v8, s[28:31], s54 offen lds
  s_add_u32 s53, s99, 137216
  s_mov_b32 m0, s53
  s_add_u32 s54, s58, 172032
  buffer_load_dwordx4 v8, s[28:31], s54 offen lds
  s_add_u32 s53, s99, 138240
  s_mov_b32 m0, s53
  s_add_u32 s54, s58, 200704
  buffer_load_dwordx4 v8, s[28:31], s54 offen lds
  s_cmp_lg_u32 s14, 1
  s_cbranch_scc1 L_ng8
  s_add_u32 s15, s63, 7
  s_and_b32 s15, s15, 7
  s_lshl_b32 s15, s15, 7
  v_add_u32 v20, s15, v55
  v_add_u32 v21, 65536, v56
  ds_read_b128 v[60:63], v21
  ds_read_b128 v[76:79], v20 offset:0
  v_add_u32 v21, 65536, v57
  ds_read_b128 v[64:67], v21
  ds_read_b128 v[80:83], v20 offset:32
  v_add_u32 v21, 65536, v58
  ds_read_b128 v[68:71], v21
  ds_read_b128 v[84:87], v20 offset:64
  v_add_u32 v21, 65536, v59
  ds_read_b128 v[72:75], v21
  ds_read_b128 v[88:91], v20 offset:96
  s_waitcnt lgkmcnt(6)
  v_mfma_f32_32x32x16_bf16 v[92:107], v[76:79], v[60:63], v[92:107]
  s_waitcnt lgkmcnt(4)
  v_mfma_f32_32x32x16_bf16 v[92:107], v[80:83], v[64:67], v[92:107]
  s_waitcnt lgkmcnt(2)
  v_mfma_f32_32x32x16_bf16 v[92:107], v[84:87], v[68:71], v[92:107]
  s_waitcnt lgkmcnt(0)
  v_mfma_f32_32x32x16_bf16 v[92:107], v[88:91], v[72:75], v[92:107]
  s_mov_b32 s17, 0x3fb8aa3b
  s_mov_b32 s16, 0xc2800000
  v_mov_b32 v22, 0x42800000
  s_lshl_b32 s15, s13, 2
  s_add_u32 s15, s15, s52
  s_lshl_b32 s15, s15, 7
  s_add_u32 s15, s15, 20971520
  v_lshlrev_b32 v21, 2, v2
  s_nop 7
  v_mul_f32 v20, s17, v92
  v_med3_f32 v20, v20, s16, v22
  v_exp_f32 v20, v20
  s_nop 0

  s_mov_b64 exec, 0xffffffff
  buffer_store_dword v20, v21, s[32:35], s15 offen sc1
  s_mov_b64 exec, -1

L_ng8:
  s_waitcnt vmcnt(8)
  s_barrier
  s_lshl_b32 s58, s50, 6
  s_add_u32 s15, s52, s63
  s_add_u32 s15, s15, 0
  s_and_b32 s15, s15, 7
  s_mul_i32 s15, s15, 229376
  s_add_u32 s58, s58, s15
  s_add_u32 s53, s99, 0
  s_mov_b32 m0, s53
  s_add_u32 s54, s58, 0
  buffer_load_dwordx4 v8, s[28:31], s54 offen lds
  s_add_u32 s53, s99, 1024
  s_mov_b32 m0, s53
  s_add_u32 s54, s58, 28672
  buffer_load_dwordx4 v8, s[28:31], s54 offen lds
  s_add_u32 s53, s99, 2048
  s_mov_b32 m0, s53
  s_add_u32 s54, s58, 57344
  buffer_load_dwordx4 v8, s[28:31], s54 offen lds
  s_add_u32 s53, s99, 3072
  s_mov_b32 m0, s53
  s_add_u32 s54, s58, 86016
  buffer_load_dwordx4 v8, s[28:31], s54 offen lds
  s_add_u32 s53, s99, 4096
  s_mov_b32 m0, s53
  s_add_u32 s54, s58, 114688
  buffer_load_dwordx4 v8, s[28:31], s54 offen lds
  s_add_u32 s53, s99, 5120
  s_mov_b32 m0, s53
  s_add_u32 s54, s58, 143360
  buffer_load_dwordx4 v8, s[28:31], s54 offen lds
  s_add_u32 s53, s99, 6144
  s_mov_b32 m0, s53
  s_add_u32 s54, s58, 172032
  buffer_load_dwordx4 v8, s[28:31], s54 offen lds
  s_add_u32 s53, s99, 7168
  s_mov_b32 m0, s53
  s_add_u32 s54, s58, 200704
  buffer_load_dwordx4 v8, s[28:31], s54 offen lds
  s_waitcnt vmcnt(8)
  s_barrier
  s_lshl_b32 s58, s50, 6
  s_add_u32 s15, s52, s63
  s_add_u32 s15, s15, 4
  s_and_b32 s15, s15, 7
  s_mul_i32 s15, s15, 229376
  s_add_u32 s58, s58, s15
  s_add_u32 s53, s99, 32768
  s_mov_b32 m0, s53
  s_add_u32 s54, s58, 0
  buffer_load_dwordx4 v8, s[28:31], s54 offen lds
  s_add_u32 s53, s99, 33792
  s_mov_b32 m0, s53
  s_add_u32 s54, s58, 28672
  buffer_load_dwordx4 v8, s[28:31], s54 offen lds
  s_add_u32 s53, s99, 34816
  s_mov_b32 m0, s53
  s_add_u32 s54, s58, 57344
  buffer_load_dwordx4 v8, s[28:31], s54 offen lds
  s_add_u32 s53, s99, 35840
  s_mov_b32 m0, s53
  s_add_u32 s54, s58, 86016
  buffer_load_dwordx4 v8, s[28:31], s54 offen lds
  s_add_u32 s53, s99, 36864
  s_mov_b32 m0, s53
  s_add_u32 s54, s58, 114688
  buffer_load_dwordx4 v8, s[28:31], s54 offen lds
  s_add_u32 s53, s99, 37888
  s_mov_b32 m0, s53
  s_add_u32 s54, s58, 143360
  buffer_load_dwordx4 v8, s[28:31], s54 offen lds
  s_add_u32 s53, s99, 38912
  s_mov_b32 m0, s53
  s_add_u32 s54, s58, 172032
  buffer_load_dwordx4 v8, s[28:31], s54 offen lds
  s_add_u32 s53, s99, 39936
  s_mov_b32 m0, s53
  s_add_u32 s54, s58, 200704
  buffer_load_dwordx4 v8, s[28:31], s54 offen lds
  v_readfirstlane_b32 s72, v52
  v_readfirstlane_b32 s73, v53
  s_cmp_lg_u32 s72, 0
  s_cbranch_scc1 L_tokok9
  v_mov_b32 v54, 0
  s_mov_b32 s95, 0
L_tok10:
  buffer_load_dwordx2 v[52:53], v54, s[64:67], 0 offen sc1
  s_add_u32 s95, s95, 1
  s_waitcnt vmcnt(0)
  v_readfirstlane_b32 s72, v52
  v_readfirstlane_b32 s73, v53
  s_cmp_gt_u32 s95, 20000
  s_cbranch_scc1 L_tokd10
  s_cmp_eq_u32 s72, 0
  s_cbranch_scc1 L_tok10

L_tokd10:
L_tokok9:
  s_and_b32 s56, s2, 7
  s_lshl_b32 s56, s56, 2
  s_lshr_b32 s15, s2, 3
  s_and_b32 s16, s15, 3
  s_add_u32 s56, s56, s16
  s_lshr_b32 s48, s15, 2
  s_lshl_b32 s57, s48, 3
  s_add_u32 s57, s57, s12
  s_lshl_b32 s58, s56, 17
  s_add_u32 s58, s58, 2097152

  s_mov_b32 s11, 1
  s_branch L_attL
L_lodd:
  s_waitcnt vmcnt(11)
  s_barrier
  s_lshl_b32 s58, s19, 6
  s_add_u32 s15, s52, s63
  s_add_u32 s15, s15, 4
  s_and_b32 s15, s15, 7
  s_mul_i32 s15, s15, 229376
  s_add_u32 s58, s58, s15
  s_add_u32 s53, s99, 131072
  s_mov_b32 m0, s53
  s_add_u32 s54, s58, 0
  buffer_load_dwordx4 v8, s[28:31], s54 offen lds
  s_add_u32 s53, s99, 132096
  s_mov_b32 m0, s53
  s_add_u32 s54, s58, 28672
  buffer_load_dwordx4 v8, s[28:31], s54 offen lds
  s_add_u32 s53, s99, 133120
  s_mov_b32 m0, s53
  s_add_u32 s54, s58, 57344
  buffer_load_dwordx4 v8, s[28:31], s54 offen lds
  s_add_u32 s53, s99, 134144
  s_mov_b32 m0, s53
  s_add_u32 s54, s58, 86016
  buffer_load_dwordx4 v8, s[28:31], s54 offen lds
  s_add_u32 s53, s99, 135168
  s_mov_b32 m0, s53
  s_add_u32 s54, s58, 114688
  buffer_load_dwordx4 v8, s[28:31], s54 offen lds
  s_add_u32 s53, s99, 136192
  s_mov_b32 m0, s53
  s_add_u32 s54, s58, 143360
  buffer_load_dwordx4 v8, s[28:31], s54 offen lds
  s_add_u32 s53, s99, 137216
  s_mov_b32 m0, s53
  s_add_u32 s54, s58, 172032
  buffer_load_dwordx4 v8, s[28:31], s54 offen lds
  s_add_u32 s53, s99, 138240
  s_mov_b32 m0, s53
  s_add_u32 s54, s58, 200704
  buffer_load_dwordx4 v8, s[28:31], s54 offen lds
  s_waitcnt vmcnt(8)
  s_barrier
  s_lshl_b32 s58, s50, 6
  s_lshl_b32 s15, s52, 1
  s_add_u32 s15, s15, s63
  s_add_u32 s15, s15, 0
  s_and_b32 s15, s15, 7
  s_mul_i32 s15, s15, 229376
  s_add_u32 s58, s58, s15
  s_add_u32 s53, s99, 0
  s_mov_b32 m0, s53
  s_add_u32 s54, s58, 0
  buffer_load_dwordx4 v9, s[28:31], s54 offen lds
  s_add_u32 s53, s99, 1024
  s_mov_b32 m0, s53
  s_add_u32 s54, s58, 57344
  buffer_load_dwordx4 v9, s[28:31], s54 offen lds
  s_add_u32 s53, s99, 2048
  s_mov_b32 m0, s53
  s_add_u32 s54, s58, 114688
  buffer_load_dwordx4 v9, s[28:31], s54 offen lds
  s_add_u32 s53, s99, 3072
  s_mov_b32 m0, s53
  s_add_u32 s54, s58, 172032
  buffer_load_dwordx4 v9, s[28:31], s54 offen lds
  s_lshl_b32 s58, s50, 6
  s_lshl_b32 s15, s52, 1
  s_add_u32 s15, s15, s63
  s_add_u32 s15, s15, 1
  s_and_b32 s15, s15, 7
  s_mul_i32 s15, s15, 229376
  s_add_u32 s58, s58, s15
  s_add_u32 s53, s99, 4096
  s_mov_b32 m0, s53
  s_add_u32 s54, s58, 0
  buffer_load_dwordx4 v9, s[28:31], s54 offen lds
  s_add_u32 s53, s99, 5120
  s_mov_b32 m0, s53
  s_add_u32 s54, s58, 57344
  buffer_load_dwordx4 v9, s[28:31], s54 offen lds
  s_add_u32 s53, s99, 6144
  s_mov_b32 m0, s53
  s_add_u32 s54, s58, 114688
  buffer_load_dwordx4 v9, s[28:31], s54 offen lds
  s_add_u32 s53, s99, 7168
  s_mov_b32 m0, s53
  s_add_u32 s54, s58, 172032
  buffer_load_dwordx4 v9, s[28:31], s54 offen lds
  s_waitcnt vmcnt(8)
  s_barrier
  s_cmp_lt_u32 s100, 32
  s_cselect_b32 s36, s8, s46
  s_cselect_b32 s37, s9, s47
  s_mov_b32 s38, 1835008
  s_cselect_b32 s38, 524288, s38
  s_cselect_b32 s15, 0, 32
  s_sub_u32 s15, s100, s15
  s_mov_b32 s4, s46
  s_mov_b32 s5, s47
  s_mov_b32 s6, 1835008
  s_mov_b32 s7, 0x00020000

  s_lshl_b32 s58, s15, 14
  s_lshl_b32 s15, s52, 8
  s_add_u32 s58, s58, s15

  s_add_u32 s53, s96, 32768
  s_mov_b32 m0, s53
  s_add_u32 s54, s58, 0
  buffer_load_dwordx4 v16, s[36:39], s54 offen nt lds
  s_add_u32 s53, s96, 33792
  s_mov_b32 m0, s53
  s_add_u32 s54, s58, 4096
  buffer_load_dwordx4 v16, s[36:39], s54 offen nt lds
  s_add_u32 s53, s96, 34816
  s_mov_b32 m0, s53
  s_add_u32 s54, s58, 8192
  buffer_load_dwordx4 v16, s[36:39], s54 offen nt lds
  s_add_u32 s53, s96, 35840
  s_mov_b32 m0, s53
  s_add_u32 s54, s58, 12288
  buffer_load_dwordx4 v16, s[36:39], s54 offen nt lds
  s_add_u32 s15, s100, 96
  s_lshl_b32 s58, s15, 14
  s_lshl_b32 s15, s52, 8
  s_add_u32 s58, s58, s15

  s_add_u32 s53, s96, 49152
  s_mov_b32 m0, s53
  s_add_u32 s54, s58, 0
  buffer_load_dwordx4 v16, s[4:7], s54 offen nt lds
  s_add_u32 s53, s96, 50176
  s_mov_b32 m0, s53
  s_add_u32 s54, s58, 4096
  buffer_load_dwordx4 v16, s[4:7], s54 offen nt lds
  s_add_u32 s53, s96, 51200
  s_mov_b32 m0, s53
  s_add_u32 s54, s58, 8192
  buffer_load_dwordx4 v16, s[4:7], s54 offen nt lds
  s_add_u32 s53, s96, 52224
  s_mov_b32 m0, s53
  s_add_u32 s54, s58, 12288
  buffer_load_dwordx4 v16, s[4:7], s54 offen nt lds
  v_readfirstlane_b32 s72, v52
  v_readfirstlane_b32 s73, v53
  s_cmp_lg_u32 s72, 0
  s_cbranch_scc1 L_tokok11
  v_mov_b32 v54, 0
  s_mov_b32 s95, 0
L_tok12:
  buffer_load_dwordx2 v[52:53], v54, s[64:67], 0 offen sc1
  s_add_u32 s95, s95, 1
  s_waitcnt vmcnt(0)
  v_readfirstlane_b32 s72, v52
  v_readfirstlane_b32 s73, v53
  s_cmp_gt_u32 s95, 20000
  s_cbranch_scc1 L_tokd12
  s_cmp_eq_u32 s72, 0
  s_cbranch_scc1 L_tok12

L_tokd12:
L_tokok11:
  s_and_b32 s56, s2, 7
  s_lshl_b32 s56, s56, 2
  s_lshr_b32 s15, s2, 3
  s_and_b32 s16, s15, 3
  s_add_u32 s56, s56, s16
  s_lshr_b32 s48, s15, 2
  s_lshl_b32 s57, s48, 3
  s_add_u32 s57, s57, s12
  s_lshl_b32 s58, s56, 17
  s_add_u32 s58, s58, 2097152

  s_mul_i32 s15, s52, 589824
  s_lshl_b32 s16, s100, 10
  s_add_u32 s15, s15, s16
  s_add_u32 s60, s15, 16842752
  s_add_u32 s61, s60, 131072
  s_lshl_b32 s15, s52, 14
  s_lshl_b32 s16, s100, 7
  s_add_u32 s49, s15, s16
  s_add_u32 s49, s49, 25427968
  s_min_u32 s11, s52, 1
  s_lshl_b32 s11, s11, 1

  s_branch L_attL

L_comp:
  v_lshlrev_b32 v3, 4, v2
  s_lshl_b32 s18, s13, 2
  s_add_u32 s18, s18, s12
  v_and_b32 v1, 31, v2
  v_lshlrev_b32 v12, 7, v1
  s_lshl_b32 s15, s12, 12
  v_add_u32 v12, s15, v12
  v_lshrrev_b32 v13, 5, v2
  v_bfe_u32 v14, v2, 1, 3

  v_or_b32 v15, 0, v13
  v_xor_b32 v15, v15, v14
  v_lshl_add_u32 v4, v15, 4, v12
  v_or_b32 v15, 2, v13
  v_xor_b32 v15, v15, v14
  v_lshl_add_u32 v5, v15, 4, v12
  v_or_b32 v15, 4, v13
  v_xor_b32 v15, v15, v14
  v_lshl_add_u32 v6, v15, 4, v12
  v_or_b32 v15, 6, v13
  v_xor_b32 v15, v15, v14
  v_lshl_add_u32 v7, v15, 4, v12
  v_bfe_u32 v12, v2, 4, 1
  v_lshlrev_b32 v12, 5, v12
  v_and_b32 v13, 3, v2
  v_lshl_add_u32 v12, v13, 3, v12
  v_lshrrev_b32 v13, 5, v2
  v_lshlrev_b32 v13, 3, v13
  v_bfe_u32 v14, v2, 2, 2
  v_add_u32 v13, v13, v14
  v_lshl_add_u32 v10, v13, 6, v12
  v_lshl_add_u32 v8, v13, 7, v12
  v_bfe_u32 v14, v2, 3, 1
  v_lshl_add_u32 v8, v14, 6, v8
  v_xor_b32 v9, 64, v8
  v_bfe_u32 v12, v2, 4, 1
  v_lshlrev_b32 v12, 17, v12
  v_lshrrev_b32 v13, 5, v2
  v_lshl_add_u32 v12, v13, 8, v12
  v_and_b32 v13, 15, v2
  v_lshl_add_u32 v11, v13, 4, v12
  v_mov_b32 v20, -1
  v_mov_b32 v21, -1
  v_mov_b32 v22, -1
  v_mov_b32 v23, -1
  s_lshl_b32 s15, s18, 15
  s_lshl_b32 s16, s14, 11
  s_add_u32 s15, s15, s16
  s_add_u32 s17, s15, 6291456
  s_mov_b32 s11, 0

  s_waitcnt lgkmcnt(0)
  s_mov_b32 s20, s4
  s_mov_b32 s21, s5
  s_mov_b32 s24, s6
  s_mov_b32 s25, s7
  s_mov_b32 s28, s44
  s_mov_b32 s29, s45
  s_mov_b32 s32, s62
  s_mov_b32 s33, s63
  s_mov_b32 s40, s52
  s_mov_b32 s41, s53
  s_mov_b32 s64, s60
  s_mov_b32 s65, s61
  s_mov_b32 s68, s54
  s_mov_b32 s69, s55

  s_mov_b32 s99, s17
  s_lshl_b32 s52, s59, 14
  s_lshl_b32 s15, s13, 10
  s_add_u32 s52, s52, s15
  s_lshl_b32 s15, s51, 9
  s_add_u32 s52, s52, s15
  s_lshl_b32 s15, s12, 7
  s_add_u32 s52, s52, s15
  s_add_u32 s52, s52, 25165824
  s_lshl_b32 s49, s18, 11
  s_lshl_b32 s15, s14, 7
  s_add_u32 s49, s49, s15
  s_add_u32 s49, s49, 25296896

  s_lshl_b32 s53, s14, 18
  s_lshl_b32 s16, s18, 10
  s_add_u32 s53, s53, s16
  s_add_u32 s53, s53, 2162688
  s_add_u32 s15, s51, 18
  s_lshl_b32 s54, s59, s15
  s_add_u32 s54, s54, s16
  s_mul_i32 s15, s51, 2097152
  s_add_u32 s54, s54, s15
  s_add_u32 s15, s51, 16
  s_lshl_b32 s55, 1, s15

  s_barrier
  ds_read_b128 v[128:131], v4 offset:0
  ds_read_b64_tr_b16 v[28:29], v10 offset:24576
  ds_read_b64_tr_b16 v[30:31], v10 offset:24832
  ds_read_b64_tr_b16 v[32:33], v8 offset:16384
  ds_read_b64_tr_b16 v[34:35], v8 offset:16896
  ds_read_b64_tr_b16 v[36:37], v9 offset:16384
  ds_read_b64_tr_b16 v[38:39], v9 offset:16896
  ds_read_b128 v[132:135], v5 offset:0
  ds_read_b64_tr_b16 v[40:41], v10 offset:25600
  ds_read_b64_tr_b16 v[42:43], v10 offset:25856
  ds_read_b64_tr_b16 v[44:45], v8 offset:18432
  ds_read_b64_tr_b16 v[46:47], v8 offset:18944
  ds_read_b64_tr_b16 v[48:49], v9 offset:18432
  ds_read_b64_tr_b16 v[50:51], v9 offset:18944
  s_waitcnt lgkmcnt(9)
  v_mfma_f32_32x32x16_bf16 v[92:107], v[128:131], v[28:31], 0
  ds_read_b128 v[136:139], v6 offset:0
  ds_read_b64_tr_b16 v[52:53], v10 offset:26624
  ds_read_b64_tr_b16 v[54:55], v10 offset:26880
  v_mfma_f32_32x32x16_bf16 v[60:75], v[32:35], v[128:131], 0
  ds_read_b64_tr_b16 v[56:57], v8 offset:20480
  ds_read_b64_tr_b16 v[58:59], v8 offset:20992
  s_waitcnt lgkmcnt(9)
  v_mfma_f32_32x32x16_bf16 v[76:91], v[36:39], v[128:131], 0
  ds_read_b64_tr_b16 v[28:29], v9 offset:20480
  ds_read_b64_tr_b16 v[30:31], v9 offset:20992
  v_mfma_f32_32x32x16_bf16 v[92:107], v[132:135], v[40:43], v[92:107]
  ds_read_b128 v[140:143], v7 offset:0
  ds_read_b64_tr_b16 v[32:33], v10 offset:27648
  ds_read_b64_tr_b16 v[34:35], v10 offset:27904
  s_waitcnt lgkmcnt(10)
  v_mfma_f32_32x32x16_bf16 v[60:75], v[44:47], v[132:135], v[60:75]
  ds_read_b64_tr_b16 v[36:37], v8 offset:22528
  ds_read_b64_tr_b16 v[38:39], v8 offset:23040
  v_mfma_f32_32x32x16_bf16 v[76:91], v[48:51], v[132:135], v[76:91]
  ds_read_b64_tr_b16 v[40:41], v9 offset:22528
  ds_read_b64_tr_b16 v[42:43], v9 offset:23040
  s_waitcnt lgkmcnt(9)
  v_mfma_f32_32x32x16_bf16 v[92:107], v[136:139], v[52:55], v[92:107]
  s_barrier
  ds_read_b128 v[144:147], v4 offset:32768
  ds_read_b64_tr_b16 v[44:45], v10 offset:57344
  ds_read_b64_tr_b16 v[46:47], v10 offset:57600
  v_mfma_f32_32x32x16_bf16 v[60:75], v[56:59], v[136:139], v[60:75]
  ds_read_b64_tr_b16 v[48:49], v8 offset:49152
  ds_read_b64_tr_b16 v[50:51], v8 offset:49664
  s_waitcnt lgkmcnt(9)
  v_mfma_f32_32x32x16_bf16 v[76:91], v[28:31], v[136:139], v[76:91]
  ds_read_b64_tr_b16 v[52:53], v9 offset:49152
  ds_read_b64_tr_b16 v[54:55], v9 offset:49664
  v_mfma_f32_32x32x16_bf16 v[92:107], v[140:143], v[32:35], v[92:107]
  ds_read_b128 v[148:151], v5 offset:32768
  ds_read_b64_tr_b16 v[56:57], v10 offset:58368
  ds_read_b64_tr_b16 v[58:59], v10 offset:58624
  s_waitcnt lgkmcnt(10)
  v_mfma_f32_32x32x16_bf16 v[60:75], v[36:39], v[140:143], v[60:75]
  ds_read_b64_tr_b16 v[28:29], v8 offset:51200
  ds_read_b64_tr_b16 v[30:31], v8 offset:51712
  v_mfma_f32_32x32x16_bf16 v[76:91], v[40:43], v[140:143], v[76:91]
  ds_read_b64_tr_b16 v[32:33], v9 offset:51200
  ds_read_b64_tr_b16 v[34:35], v9 offset:51712
  s_waitcnt lgkmcnt(9)
  v_mfma_f32_32x32x16_bf16 v[92:107], v[144:147], v[44:47], v[92:107]
  ds_read_b128 v[152:155], v6 offset:32768
  ds_read_b64_tr_b16 v[36:37], v10 offset:59392
  ds_read_b64_tr_b16 v[38:39], v10 offset:59648
  v_mfma_f32_32x32x16_bf16 v[60:75], v[48:51], v[144:147], v[60:75]
  ds_read_b64_tr_b16 v[40:41], v8 offset:53248
  ds_read_b64_tr_b16 v[42:43], v8 offset:53760
  s_waitcnt lgkmcnt(9)
  v_mfma_f32_32x32x16_bf16 v[76:91], v[52:55], v[144:147], v[76:91]
  ds_read_b64_tr_b16 v[44:45], v9 offset:53248
  ds_read_b64_tr_b16 v[46:47], v9 offset:53760
  v_mfma_f32_32x32x16_bf16 v[92:107], v[148:151], v[56:59], v[92:107]
  ds_read_b128 v[156:159], v7 offset:32768
  ds_read_b64_tr_b16 v[48:49], v10 offset:60416
  ds_read_b64_tr_b16 v[50:51], v10 offset:60672
  s_waitcnt lgkmcnt(10)
  v_mfma_f32_32x32x16_bf16 v[60:75], v[28:31], v[148:151], v[60:75]
  ds_read_b64_tr_b16 v[52:53], v8 offset:55296
  ds_read_b64_tr_b16 v[54:55], v8 offset:55808
  v_mfma_f32_32x32x16_bf16 v[76:91], v[32:35], v[148:151], v[76:91]
  ds_read_b64_tr_b16 v[56:57], v9 offset:55296
  ds_read_b64_tr_b16 v[58:59], v9 offset:55808
  s_waitcnt lgkmcnt(9)
  v_mfma_f32_32x32x16_bf16 v[92:107], v[152:155], v[36:39], v[92:107]
  s_barrier
  v_add_u32 v4, 65536, v4
  ds_read_b128 v[160:163], v4 offset:0
  v_add_u32 v10, 65536, v10
  ds_read_b64_tr_b16 v[28:29], v10 offset:24576
  ds_read_b64_tr_b16 v[30:31], v10 offset:24832
  v_mfma_f32_32x32x16_bf16 v[60:75], v[40:43], v[152:155], v[60:75]
  v_add_u32 v8, 65536, v8
  ds_read_b64_tr_b16 v[32:33], v8 offset:16384
  ds_read_b64_tr_b16 v[34:35], v8 offset:16896
  s_waitcnt lgkmcnt(9)
  v_mfma_f32_32x32x16_bf16 v[76:91], v[44:47], v[152:155], v[76:91]
  v_add_u32 v9, 65536, v9
  ds_read_b64_tr_b16 v[36:37], v9 offset:16384
  ds_read_b64_tr_b16 v[38:39], v9 offset:16896
  v_mfma_f32_32x32x16_bf16 v[92:107], v[156:159], v[48:51], v[92:107]
  v_add_u32 v5, 65536, v5
  ds_read_b128 v[164:167], v5 offset:0
  ds_read_b64_tr_b16 v[40:41], v10 offset:25600
  ds_read_b64_tr_b16 v[42:43], v10 offset:25856
  s_waitcnt lgkmcnt(10)
  v_mfma_f32_32x32x16_bf16 v[60:75], v[52:55], v[156:159], v[60:75]
  ds_read_b64_tr_b16 v[44:45], v8 offset:18432
  ds_read_b64_tr_b16 v[46:47], v8 offset:18944
  v_mfma_f32_32x32x16_bf16 v[76:91], v[56:59], v[156:159], v[76:91]
  ds_read_b64_tr_b16 v[48:49], v9 offset:18432
  ds_read_b64_tr_b16 v[50:51], v9 offset:18944
  s_waitcnt lgkmcnt(9)
  v_mfma_f32_32x32x16_bf16 v[92:107], v[160:163], v[28:31], v[92:107]
  v_add_u32 v6, 65536, v6
  ds_read_b128 v[168:171], v6 offset:0
  ds_read_b64_tr_b16 v[52:53], v10 offset:26624
  ds_read_b64_tr_b16 v[54:55], v10 offset:26880
  v_mfma_f32_32x32x16_bf16 v[60:75], v[32:35], v[160:163], v[60:75]
  ds_read_b64_tr_b16 v[56:57], v8 offset:20480
  ds_read_b64_tr_b16 v[58:59], v8 offset:20992
  s_waitcnt lgkmcnt(9)
  v_mfma_f32_32x32x16_bf16 v[76:91], v[36:39], v[160:163], v[76:91]
  ds_read_b64_tr_b16 v[28:29], v9 offset:20480
  ds_read_b64_tr_b16 v[30:31], v9 offset:20992
  v_mfma_f32_32x32x16_bf16 v[92:107], v[164:167], v[40:43], v[92:107]
  v_add_u32 v7, 65536, v7
  ds_read_b128 v[172:175], v7 offset:0
  ds_read_b64_tr_b16 v[32:33], v10 offset:27648
  ds_read_b64_tr_b16 v[34:35], v10 offset:27904
  s_waitcnt lgkmcnt(10)
  v_mfma_f32_32x32x16_bf16 v[60:75], v[44:47], v[164:167], v[60:75]
  ds_read_b64_tr_b16 v[36:37], v8 offset:22528
  ds_read_b64_tr_b16 v[38:39], v8 offset:23040
  v_mfma_f32_32x32x16_bf16 v[76:91], v[48:51], v[164:167], v[76:91]
  ds_read_b64_tr_b16 v[40:41], v9 offset:22528
  ds_read_b64_tr_b16 v[42:43], v9 offset:23040
  s_waitcnt lgkmcnt(9)
  v_mfma_f32_32x32x16_bf16 v[92:107], v[168:171], v[52:55], v[92:107]
  s_barrier
  ds_read_b128 v[176:179], v4 offset:32768
  ds_read_b64_tr_b16 v[44:45], v10 offset:57344
  ds_read_b64_tr_b16 v[46:47], v10 offset:57600
  v_mfma_f32_32x32x16_bf16 v[60:75], v[56:59], v[168:171], v[60:75]
  ds_read_b64_tr_b16 v[48:49], v8 offset:49152
  ds_read_b64_tr_b16 v[50:51], v8 offset:49664
  s_waitcnt lgkmcnt(9)
  v_mfma_f32_32x32x16_bf16 v[76:91], v[28:31], v[168:171], v[76:91]
  ds_read_b64_tr_b16 v[52:53], v9 offset:49152
  ds_read_b64_tr_b16 v[54:55], v9 offset:49664
  v_mfma_f32_32x32x16_bf16 v[92:107], v[172:175], v[32:35], v[92:107]
  ds_read_b128 v[180:183], v5 offset:32768
  ds_read_b64_tr_b16 v[56:57], v10 offset:58368
  ds_read_b64_tr_b16 v[58:59], v10 offset:58624
  s_waitcnt lgkmcnt(10)
  v_mfma_f32_32x32x16_bf16 v[60:75], v[36:39], v[172:175], v[60:75]
  ds_read_b64_tr_b16 v[28:29], v8 offset:51200
  ds_read_b64_tr_b16 v[30:31], v8 offset:51712
  v_mfma_f32_32x32x16_bf16 v[76:91], v[40:43], v[172:175], v[76:91]
  ds_read_b64_tr_b16 v[32:33], v9 offset:51200
  ds_read_b64_tr_b16 v[34:35], v9 offset:51712
  s_waitcnt lgkmcnt(9)
  v_mfma_f32_32x32x16_bf16 v[92:107], v[176:179], v[44:47], v[92:107]
  ds_read_b128 v[184:187], v6 offset:32768
  ds_read_b64_tr_b16 v[36:37], v10 offset:59392
  ds_read_b64_tr_b16 v[38:39], v10 offset:59648
  v_mfma_f32_32x32x16_bf16 v[60:75], v[48:51], v[176:179], v[60:75]
  ds_read_b64_tr_b16 v[40:41], v8 offset:53248
  ds_read_b64_tr_b16 v[42:43], v8 offset:53760
  s_waitcnt lgkmcnt(9)
  v_mfma_f32_32x32x16_bf16 v[76:91], v[52:55], v[176:179], v[76:91]
  ds_read_b64_tr_b16 v[44:45], v9 offset:53248
  ds_read_b64_tr_b16 v[46:47], v9 offset:53760
  v_mfma_f32_32x32x16_bf16 v[92:107], v[180:183], v[56:59], v[92:107]
  ds_read_b128 v[188:191], v7 offset:32768
  ds_read_b64_tr_b16 v[48:49], v10 offset:60416
  ds_read_b64_tr_b16 v[50:51], v10 offset:60672
  s_waitcnt lgkmcnt(10)
  v_mfma_f32_32x32x16_bf16 v[60:75], v[28:31], v[180:183], v[60:75]
  ds_read_b64_tr_b16 v[52:53], v8 offset:55296
  ds_read_b64_tr_b16 v[54:55], v8 offset:55808
  v_mfma_f32_32x32x16_bf16 v[76:91], v[32:35], v[180:183], v[76:91]
  ds_read_b64_tr_b16 v[56:57], v9 offset:55296
  ds_read_b64_tr_b16 v[58:59], v9 offset:55808
  s_waitcnt lgkmcnt(9)
  v_mfma_f32_32x32x16_bf16 v[92:107], v[184:187], v[36:39], v[92:107]
  s_barrier
  v_add_u32 v4, 65536, v4
  ds_read_b128 v[192:195], v4 offset:0
  v_add_u32 v10, 65536, v10
  ds_read_b64_tr_b16 v[28:29], v10 offset:24576
  ds_read_b64_tr_b16 v[30:31], v10 offset:24832
  v_mfma_f32_32x32x16_bf16 v[60:75], v[40:43], v[184:187], v[60:75]
  v_add_u32 v8, 65536, v8
  ds_read_b64_tr_b16 v[32:33], v8 offset:16384
  ds_read_b64_tr_b16 v[34:35], v8 offset:16896
  s_waitcnt lgkmcnt(9)
  v_mfma_f32_32x32x16_bf16 v[76:91], v[44:47], v[184:187], v[76:91]
  v_add_u32 v9, 65536, v9
  ds_read_b64_tr_b16 v[36:37], v9 offset:16384
  ds_read_b64_tr_b16 v[38:39], v9 offset:16896
  v_mfma_f32_32x32x16_bf16 v[92:107], v[188:191], v[48:51], v[92:107]
  v_add_u32 v5, 65536, v5
  ds_read_b128 v[196:199], v5 offset:0
  ds_read_b64_tr_b16 v[40:41], v10 offset:25600
  ds_read_b64_tr_b16 v[42:43], v10 offset:25856
  s_waitcnt lgkmcnt(10)
  v_mfma_f32_32x32x16_bf16 v[60:75], v[52:55], v[188:191], v[60:75]
  ds_read_b64_tr_b16 v[44:45], v8 offset:18432
  ds_read_b64_tr_b16 v[46:47], v8 offset:18944
  v_mfma_f32_32x32x16_bf16 v[76:91], v[56:59], v[188:191], v[76:91]
  ds_read_b64_tr_b16 v[48:49], v9 offset:18432
  ds_read_b64_tr_b16 v[50:51], v9 offset:18944
  s_waitcnt lgkmcnt(9)
  v_mfma_f32_32x32x16_bf16 v[92:107], v[192:195], v[28:31], v[92:107]
  v_add_u32 v6, 65536, v6
  ds_read_b128 v[200:203], v6 offset:0
  ds_read_b64_tr_b16 v[52:53], v10 offset:26624
  ds_read_b64_tr_b16 v[54:55], v10 offset:26880
  v_mfma_f32_32x32x16_bf16 v[60:75], v[32:35], v[192:195], v[60:75]
  ds_read_b64_tr_b16 v[56:57], v8 offset:20480
  ds_read_b64_tr_b16 v[58:59], v8 offset:20992
  s_waitcnt lgkmcnt(9)
  v_mfma_f32_32x32x16_bf16 v[76:91], v[36:39], v[192:195], v[76:91]
  ds_read_b64_tr_b16 v[28:29], v9 offset:20480
  ds_read_b64_tr_b16 v[30:31], v9 offset:20992
  v_mfma_f32_32x32x16_bf16 v[92:107], v[196:199], v[40:43], v[92:107]
  v_add_u32 v7, 65536, v7
  ds_read_b128 v[204:207], v7 offset:0
  ds_read_b64_tr_b16 v[32:33], v10 offset:27648
  ds_read_b64_tr_b16 v[34:35], v10 offset:27904
  s_waitcnt lgkmcnt(10)
  v_mfma_f32_32x32x16_bf16 v[60:75], v[44:47], v[196:199], v[60:75]
  ds_read_b64_tr_b16 v[36:37], v8 offset:22528
  ds_read_b64_tr_b16 v[38:39], v8 offset:23040
  v_mfma_f32_32x32x16_bf16 v[76:91], v[48:51], v[196:199], v[76:91]
  ds_read_b64_tr_b16 v[40:41], v9 offset:22528
  ds_read_b64_tr_b16 v[42:43], v9 offset:23040
  s_waitcnt lgkmcnt(9)
  v_mfma_f32_32x32x16_bf16 v[92:107], v[200:203], v[52:55], v[92:107]
  s_barrier
  v_subrev_u32 v4, 131072, v4
  ds_read_b128 v[208:211], v4 offset:0
  v_subrev_u32 v10, 131072, v10
  ds_read_b64_tr_b16 v[44:45], v10 offset:24576
  ds_read_b64_tr_b16 v[46:47], v10 offset:24832
  v_mfma_f32_32x32x16_bf16 v[60:75], v[56:59], v[200:203], v[60:75]
  v_subrev_u32 v8, 131072, v8
  ds_read_b64_tr_b16 v[48:49], v8 offset:16384
  ds_read_b64_tr_b16 v[50:51], v8 offset:16896
  s_waitcnt lgkmcnt(9)
  v_mfma_f32_32x32x16_bf16 v[76:91], v[28:31], v[200:203], v[76:91]
  v_subrev_u32 v9, 131072, v9
  ds_read_b64_tr_b16 v[52:53], v9 offset:16384
  ds_read_b64_tr_b16 v[54:55], v9 offset:16896
  v_mfma_f32_32x32x16_bf16 v[92:107], v[204:207], v[32:35], v[92:107]
  v_subrev_u32 v5, 131072, v5
  ds_read_b128 v[212:215], v5 offset:0
  ds_read_b64_tr_b16 v[56:57], v10 offset:25600
  ds_read_b64_tr_b16 v[58:59], v10 offset:25856
  s_waitcnt lgkmcnt(10)
  v_mfma_f32_32x32x16_bf16 v[60:75], v[36:39], v[204:207], v[60:75]
  ds_read_b64_tr_b16 v[28:29], v8 offset:18432
  ds_read_b64_tr_b16 v[30:31], v8 offset:18944
  v_mfma_f32_32x32x16_bf16 v[76:91], v[40:43], v[204:207], v[76:91]
  ds_read_b64_tr_b16 v[32:33], v9 offset:18432
  ds_read_b64_tr_b16 v[34:35], v9 offset:18944
  s_waitcnt lgkmcnt(9)
  v_mfma_f32_32x32x16_bf16 v[92:107], v[208:211], v[44:47], v[92:107]
  v_subrev_u32 v6, 131072, v6
  ds_read_b128 v[216:219], v6 offset:0
  ds_read_b64_tr_b16 v[36:37], v10 offset:26624
  ds_read_b64_tr_b16 v[38:39], v10 offset:26880
  v_mov_b32 v126, 0
  buffer_load_dwordx2 v[124:125], v126, s[64:67], 0 offen sc1
  v_mfma_f32_32x32x16_bf16 v[60:75], v[48:51], v[208:211], v[60:75]
  ds_read_b64_tr_b16 v[40:41], v8 offset:20480
  ds_read_b64_tr_b16 v[42:43], v8 offset:20992
  s_waitcnt lgkmcnt(9)
  v_mfma_f32_32x32x16_bf16 v[76:91], v[52:55], v[208:211], v[76:91]
  ds_read_b64_tr_b16 v[44:45], v9 offset:20480
  ds_read_b64_tr_b16 v[46:47], v9 offset:20992
  v_mfma_f32_32x32x16_bf16 v[92:107], v[212:215], v[56:59], v[92:107]
  v_subrev_u32 v7, 131072, v7
  ds_read_b128 v[220:223], v7 offset:0
  ds_read_b64_tr_b16 v[48:49], v10 offset:27648
  ds_read_b64_tr_b16 v[50:51], v10 offset:27904
  s_waitcnt lgkmcnt(10)
  v_mfma_f32_32x32x16_bf16 v[60:75], v[28:31], v[212:215], v[60:75]
  ds_read_b64_tr_b16 v[52:53], v8 offset:22528
  ds_read_b64_tr_b16 v[54:55], v8 offset:23040
  v_mfma_f32_32x32x16_bf16 v[76:91], v[32:35], v[212:215], v[76:91]
  ds_read_b64_tr_b16 v[56:57], v9 offset:22528
  ds_read_b64_tr_b16 v[58:59], v9 offset:23040
  s_waitcnt lgkmcnt(9)
  v_mfma_f32_32x32x16_bf16 v[92:107], v[216:219], v[36:39], v[92:107]
  s_barrier
  ds_read_b128 v[224:227], v4 offset:32768
  ds_read_b64_tr_b16 v[28:29], v10 offset:57344
  ds_read_b64_tr_b16 v[30:31], v10 offset:57600
  v_mfma_f32_32x32x16_bf16 v[60:75], v[40:43], v[216:219], v[60:75]
  ds_read_b64_tr_b16 v[32:33], v8 offset:49152
  ds_read_b64_tr_b16 v[34:35], v8 offset:49664
  s_waitcnt lgkmcnt(9)
  v_mfma_f32_32x32x16_bf16 v[76:91], v[44:47], v[216:219], v[76:91]
  ds_read_b64_tr_b16 v[36:37], v9 offset:49152
  ds_read_b64_tr_b16 v[38:39], v9 offset:49664
  v_mfma_f32_32x32x16_bf16 v[92:107], v[220:223], v[48:51], v[92:107]
  ds_read_b128 v[228:231], v5 offset:32768
  ds_read_b64_tr_b16 v[40:41], v10 offset:58368
  ds_read_b64_tr_b16 v[42:43], v10 offset:58624
  s_waitcnt lgkmcnt(10)
  v_mfma_f32_32x32x16_bf16 v[60:75], v[52:55], v[220:223], v[60:75]
  ds_read_b64_tr_b16 v[44:45], v8 offset:51200
  ds_read_b64_tr_b16 v[46:47], v8 offset:51712
  v_mfma_f32_32x32x16_bf16 v[76:91], v[56:59], v[220:223], v[76:91]
  ds_read_b64_tr_b16 v[48:49], v9 offset:51200
  ds_read_b64_tr_b16 v[50:51], v9 offset:51712
  s_waitcnt lgkmcnt(9)
  v_mfma_f32_32x32x16_bf16 v[92:107], v[224:227], v[28:31], v[92:107]
  ds_read_b128 v[232:235], v6 offset:32768
  ds_read_b64_tr_b16 v[52:53], v10 offset:59392
  ds_read_b64_tr_b16 v[54:55], v10 offset:59648
  v_mfma_f32_32x32x16_bf16 v[60:75], v[32:35], v[224:227], v[60:75]
  ds_read_b64_tr_b16 v[56:57], v8 offset:53248
  ds_read_b64_tr_b16 v[58:59], v8 offset:53760
  s_waitcnt lgkmcnt(9)
  v_mfma_f32_32x32x16_bf16 v[76:91], v[36:39], v[224:227], v[76:91]
  ds_read_b64_tr_b16 v[28:29], v9 offset:53248
  ds_read_b64_tr_b16 v[30:31], v9 offset:53760
  v_mfma_f32_32x32x16_bf16 v[92:107], v[228:231], v[40:43], v[92:107]
  ds_read_b128 v[236:239], v7 offset:32768
  ds_read_b64_tr_b16 v[32:33], v10 offset:60416
  ds_read_b64_tr_b16 v[34:35], v10 offset:60672
  s_waitcnt lgkmcnt(10)
  v_mfma_f32_32x32x16_bf16 v[60:75], v[44:47], v[228:231], v[60:75]
  ds_read_b64_tr_b16 v[36:37], v8 offset:55296
  ds_read_b64_tr_b16 v[38:39], v8 offset:55808
  v_mfma_f32_32x32x16_bf16 v[76:91], v[48:51], v[228:231], v[76:91]
  ds_read_b64_tr_b16 v[40:41], v9 offset:55296
  ds_read_b64_tr_b16 v[42:43], v9 offset:55808
  s_waitcnt lgkmcnt(9)
  v_mfma_f32_32x32x16_bf16 v[92:107], v[232:235], v[52:55], v[92:107]
  s_barrier
  v_add_u32 v4, 65536, v4
  ds_read_b128 v[240:243], v4 offset:0
  v_add_u32 v10, 65536, v10
  ds_read_b64_tr_b16 v[44:45], v10 offset:24576
  ds_read_b64_tr_b16 v[46:47], v10 offset:24832
  v_mfma_f32_32x32x16_bf16 v[60:75], v[56:59], v[232:235], v[60:75]
  v_add_u32 v8, 65536, v8
  ds_read_b64_tr_b16 v[48:49], v8 offset:16384
  ds_read_b64_tr_b16 v[50:51], v8 offset:16896
  s_waitcnt lgkmcnt(9)
  v_mfma_f32_32x32x16_bf16 v[76:91], v[28:31], v[232:235], v[76:91]
  v_add_u32 v9, 65536, v9
  ds_read_b64_tr_b16 v[52:53], v9 offset:16384
  ds_read_b64_tr_b16 v[54:55], v9 offset:16896
  v_mfma_f32_32x32x16_bf16 v[92:107], v[236:239], v[32:35], v[92:107]
  v_add_u32 v5, 65536, v5
  ds_read_b128 v[244:247], v5 offset:0
  ds_read_b64_tr_b16 v[56:57], v10 offset:25600
  ds_read_b64_tr_b16 v[58:59], v10 offset:25856
  s_waitcnt lgkmcnt(10)
  v_mfma_f32_32x32x16_bf16 v[60:75], v[36:39], v[236:239], v[60:75]
  ds_read_b64_tr_b16 v[28:29], v8 offset:18432
  ds_read_b64_tr_b16 v[30:31], v8 offset:18944
  v_mfma_f32_32x32x16_bf16 v[76:91], v[40:43], v[236:239], v[76:91]
  ds_read_b64_tr_b16 v[32:33], v9 offset:18432
  ds_read_b64_tr_b16 v[34:35], v9 offset:18944
  s_waitcnt lgkmcnt(9)
  v_mfma_f32_32x32x16_bf16 v[92:107], v[240:243], v[44:47], v[92:107]
  v_add_u32 v6, 65536, v6
  ds_read_b128 v[248:251], v6 offset:0
  ds_read_b64_tr_b16 v[36:37], v10 offset:26624
  ds_read_b64_tr_b16 v[38:39], v10 offset:26880
  v_mfma_f32_32x32x16_bf16 v[60:75], v[48:51], v[240:243], v[60:75]
  ds_read_b64_tr_b16 v[40:41], v8 offset:20480
  ds_read_b64_tr_b16 v[42:43], v8 offset:20992
  s_waitcnt lgkmcnt(9)
  v_mfma_f32_32x32x16_bf16 v[76:91], v[52:55], v[240:243], v[76:91]
  ds_read_b64_tr_b16 v[44:45], v9 offset:20480
  ds_read_b64_tr_b16 v[46:47], v9 offset:20992
  v_mfma_f32_32x32x16_bf16 v[92:107], v[244:247], v[56:59], v[92:107]
  v_add_u32 v7, 65536, v7
  ds_read_b128 v[252:255], v7 offset:0
  ds_read_b64_tr_b16 v[48:49], v10 offset:27648
  ds_read_b64_tr_b16 v[50:51], v10 offset:27904
  s_waitcnt lgkmcnt(10)
  v_mfma_f32_32x32x16_bf16 v[60:75], v[28:31], v[244:247], v[60:75]
  ds_read_b64_tr_b16 v[52:53], v8 offset:22528
  ds_read_b64_tr_b16 v[54:55], v8 offset:23040
  v_mfma_f32_32x32x16_bf16 v[76:91], v[32:35], v[244:247], v[76:91]
  ds_read_b64_tr_b16 v[56:57], v9 offset:22528
  ds_read_b64_tr_b16 v[58:59], v9 offset:23040
  s_waitcnt lgkmcnt(9)
  v_mfma_f32_32x32x16_bf16 v[92:107], v[248:251], v[36:39], v[92:107]
  v_mfma_f32_32x32x16_bf16 v[60:75], v[40:43], v[248:251], v[60:75]
  s_waitcnt lgkmcnt(4)
  v_mfma_f32_32x32x16_bf16 v[76:91], v[44:47], v[248:251], v[76:91]
  s_waitcnt vmcnt(0)
  v_readfirstlane_b32 s72, v124
  v_readfirstlane_b32 s73, v125
  s_cmp_lg_u32 s72, 0
  s_cbranch_scc1 L_tokok13
  v_mov_b32 v126, 0
  s_mov_b32 s95, 0
L_tok14:
  buffer_load_dwordx2 v[124:125], v126, s[64:67], 0 offen sc1
  s_add_u32 s95, s95, 1
  s_waitcnt vmcnt(0)
  v_readfirstlane_b32 s72, v124
  v_readfirstlane_b32 s73, v125
  s_cmp_gt_u32 s95, 20000
  s_cbranch_scc1 L_tokd14
  s_cmp_eq_u32 s72, 0
  s_cbranch_scc1 L_tok14

L_tokd14:
L_tokok13:
  v_mfma_f32_32x32x16_bf16 v[92:107], v[252:255], v[48:51], v[92:107]
  s_waitcnt lgkmcnt(0)
  v_mfma_f32_32x32x16_bf16 v[60:75], v[52:55], v[252:255], v[60:75]
  v_mfma_f32_32x32x16_bf16 v[76:91], v[56:59], v[252:255], v[76:91]
  s_cmp_lg_u32 s51, 0
  s_cselect_b32 s17, 1.0, 0x3eb8aa3b
  s_nop 8
  v_cvt_pk_bf16_f32 v92, v92, v93
  v_cvt_pk_bf16_f32 v93, v94, v95
  v_cvt_pk_bf16_f32 v94, v96, v97
  v_cvt_pk_bf16_f32 v95, v98, v99
  v_cvt_pk_bf16_f32 v96, v100, v101
  v_cvt_pk_bf16_f32 v97, v102, v103
  v_cvt_pk_bf16_f32 v98, v104, v105
  v_cvt_pk_bf16_f32 v99, v106, v107
  buffer_store_dwordx4 v[92:95], v11, s[32:35], s53 offen sc1
  buffer_store_dwordx4 v[96:99], v11, s[32:35], s53 offen offset:512 sc1
  v_mul_f32 v60, s17, v60
  v_mul_f32 v61, s17, v61
  v_mul_f32 v62, s17, v62
  v_mul_f32 v63, s17, v63
  v_mul_f32 v64, s17, v64
  v_mul_f32 v65, s17, v65
  v_mul_f32 v66, s17, v66
  v_mul_f32 v67, s17, v67
  v_mul_f32 v68, s17, v68
  v_mul_f32 v69, s17, v69
  v_mul_f32 v70, s17, v70
  v_mul_f32 v71, s17, v71
  v_mul_f32 v72, s17, v72
  v_mul_f32 v73, s17, v73
  v_mul_f32 v74, s17, v74
  v_mul_f32 v75, s17, v75
  v_cvt_pk_bf16_f32 v20, v60, v61
  v_cvt_pk_bf16_f32 v21, v62, v63
  v_cvt_pk_bf16_f32 v22, v64, v65
  v_cvt_pk_bf16_f32 v23, v66, v67
  v_cvt_pk_bf16_f32 v24, v68, v69
  v_cvt_pk_bf16_f32 v25, v70, v71
  v_cvt_pk_bf16_f32 v26, v72, v73
  v_cvt_pk_bf16_f32 v27, v74, v75
  buffer_store_dwordx4 v[20:23], v3, s[32:35], s54 offen sc1
  s_add_u32 s54, s54, s55
  buffer_store_dwordx4 v[24:27], v3, s[32:35], s54 offen sc1
  s_add_u32 s54, s54, s55
  v_mul_f32 v76, s17, v76
  v_mul_f32 v77, s17, v77
  v_mul_f32 v78, s17, v78
  v_mul_f32 v79, s17, v79
  v_mul_f32 v80, s17, v80
  v_mul_f32 v81, s17, v81
  v_mul_f32 v82, s17, v82
  v_mul_f32 v83, s17, v83
  v_mul_f32 v84, s17, v84
  v_mul_f32 v85, s17, v85
  v_mul_f32 v86, s17, v86
  v_mul_f32 v87, s17, v87
  v_mul_f32 v88, s17, v88
  v_mul_f32 v89, s17, v89
  v_mul_f32 v90, s17, v90
  v_mul_f32 v91, s17, v91
  v_cvt_pk_bf16_f32 v12, v76, v77
  v_cvt_pk_bf16_f32 v13, v78, v79
  v_cvt_pk_bf16_f32 v14, v80, v81
  v_cvt_pk_bf16_f32 v15, v82, v83
  v_cvt_pk_bf16_f32 v16, v84, v85
  v_cvt_pk_bf16_f32 v17, v86, v87
  v_cvt_pk_bf16_f32 v18, v88, v89
  v_cvt_pk_bf16_f32 v19, v90, v91
  buffer_store_dwordx4 v[12:15], v3, s[32:35], s54 offen sc1
  s_add_u32 s54, s54, s55
  buffer_store_dwordx4 v[16:19], v3, s[32:35], s54 offen sc1
  s_add_u32 s54, s54, s55
  s_barrier
  ds_read_b64_tr_b16 v[28:29], v8 offset:32768
  ds_read_b64_tr_b16 v[30:31], v8 offset:33280
  ds_read_b64_tr_b16 v[32:33], v8 offset:34816
  ds_read_b64_tr_b16 v[34:35], v8 offset:35328
  ds_read_b64_tr_b16 v[36:37], v8 offset:36864
  ds_read_b64_tr_b16 v[38:39], v8 offset:37376
  ds_read_b64_tr_b16 v[40:41], v8 offset:38912
  ds_read_b64_tr_b16 v[42:43], v8 offset:39424
  ds_read_b64_tr_b16 v[44:45], v8 offset:40960
  ds_read_b64_tr_b16 v[46:47], v8 offset:41472
  ds_read_b64_tr_b16 v[48:49], v8 offset:43008
  ds_read_b64_tr_b16 v[50:51], v8 offset:43520
  s_waitcnt lgkmcnt(10)
  v_mfma_f32_32x32x16_bf16 v[108:123], v[28:31], v[128:131], 0
  ds_read_b64_tr_b16 v[52:53], v8 offset:45056
  ds_read_b64_tr_b16 v[54:55], v8 offset:45568
  s_setprio 3
  s_waitcnt lgkmcnt(10)
  v_mfma_f32_32x32x16_bf16 v[108:123], v[32:35], v[132:135], v[108:123]
  ds_read_b64_tr_b16 v[56:57], v8 offset:47104
  ds_read_b64_tr_b16 v[58:59], v8 offset:47616
  s_waitcnt lgkmcnt(8)
  v_mfma_f32_32x32x16_bf16 v[108:123], v[36:39], v[136:139], v[108:123]
  ds_read_b64_tr_b16 v[28:29], v8 offset:49152
  ds_read_b64_tr_b16 v[30:31], v8 offset:49664
  v_mfma_f32_32x32x16_bf16 v[108:123], v[40:43], v[140:143], v[108:123]
  ds_read_b64_tr_b16 v[32:33], v8 offset:51200
  ds_read_b64_tr_b16 v[34:35], v8 offset:51712
  s_waitcnt lgkmcnt(8)
  v_mfma_f32_32x32x16_bf16 v[108:123], v[44:47], v[144:147], v[108:123]
  ds_read_b64_tr_b16 v[36:37], v8 offset:53248
  ds_read_b64_tr_b16 v[38:39], v8 offset:53760
  v_mfma_f32_32x32x16_bf16 v[108:123], v[48:51], v[148:151], v[108:123]
  ds_read_b64_tr_b16 v[40:41], v8 offset:55296
  ds_read_b64_tr_b16 v[42:43], v8 offset:55808
  s_waitcnt lgkmcnt(8)
  v_mfma_f32_32x32x16_bf16 v[108:123], v[52:55], v[152:155], v[108:123]
  ds_read_b64_tr_b16 v[44:45], v8 offset:57344
  ds_read_b64_tr_b16 v[46:47], v8 offset:57856
  v_mfma_f32_32x32x16_bf16 v[108:123], v[56:59], v[156:159], v[108:123]
  ds_read_b64_tr_b16 v[48:49], v8 offset:59392
  ds_read_b64_tr_b16 v[50:51], v8 offset:59904
  s_waitcnt lgkmcnt(8)
  v_mfma_f32_32x32x16_bf16 v[108:123], v[28:31], v[160:163], v[108:123]
  ds_read_b64_tr_b16 v[52:53], v8 offset:61440
  ds_read_b64_tr_b16 v[54:55], v8 offset:61952
  v_mfma_f32_32x32x16_bf16 v[108:123], v[32:35], v[164:167], v[108:123]
  ds_read_b64_tr_b16 v[56:57], v8 offset:63488
  ds_read_b64_tr_b16 v[58:59], v8 offset:64000
  s_waitcnt lgkmcnt(8)
  v_mfma_f32_32x32x16_bf16 v[108:123], v[36:39], v[168:171], v[108:123]
  s_barrier
  v_add_u32 v8, 65536, v8
  ds_read_b64_tr_b16 v[28:29], v8 offset:0
  ds_read_b64_tr_b16 v[30:31], v8 offset:512
  v_mfma_f32_32x32x16_bf16 v[108:123], v[40:43], v[172:175], v[108:123]
  ds_read_b64_tr_b16 v[32:33], v8 offset:2048
  ds_read_b64_tr_b16 v[34:35], v8 offset:2560
  s_waitcnt lgkmcnt(8)
  v_mfma_f32_32x32x16_bf16 v[108:123], v[44:47], v[176:179], v[108:123]
  ds_read_b64_tr_b16 v[36:37], v8 offset:4096
  ds_read_b64_tr_b16 v[38:39], v8 offset:4608
  s_lshl_b32 s15, s12, 3
  s_add_u32 s15, s15, 89088
  v_mov_b32 v22, s15
  v_and_b32 v23, 3, v2
  v_lshlrev_b32 v23, 3, v23
  v_add_u32 v23, 89088, v23
  s_waitcnt vmcnt(0)
  s_mov_b64 exec, 1
  buffer_store_dwordx2 v[124:125], v126, s[32:35], s52 offen sc1
  s_mov_b64 exec, -1
  v_mfma_f32_32x32x16_bf16 v[108:123], v[48:51], v[180:183], v[108:123]
  ds_read_b64_tr_b16 v[40:41], v8 offset:6144
  ds_read_b64_tr_b16 v[42:43], v8 offset:6656
  s_waitcnt lgkmcnt(8)
  v_mfma_f32_32x32x16_bf16 v[108:123], v[52:55], v[184:187], v[108:123]
  ds_read_b64_tr_b16 v[44:45], v8 offset:8192
  ds_read_b64_tr_b16 v[46:47], v8 offset:8704
  v_mfma_f32_32x32x16_bf16 v[108:123], v[56:59], v[188:191], v[108:123]
  ds_read_b64_tr_b16 v[48:49], v8 offset:10240
  ds_read_b64_tr_b16 v[50:51], v8 offset:10752
  s_waitcnt lgkmcnt(8)
  v_mfma_f32_32x32x16_bf16 v[108:123], v[28:31], v[192:195], v[108:123]
  ds_read_b64_tr_b16 v[52:53], v8 offset:12288
  ds_read_b64_tr_b16 v[54:55], v8 offset:12800
  v_mfma_f32_32x32x16_bf16 v[108:123], v[32:35], v[196:199], v[108:123]
  ds_read_b64_tr_b16 v[56:57], v8 offset:14336
  ds_read_b64_tr_b16 v[58:59], v8 offset:14848
  s_waitcnt lgkmcnt(8)
  v_mfma_f32_32x32x16_bf16 v[108:123], v[36:39], v[200:203], v[108:123]
  ds_read_b64_tr_b16 v[28:29], v8 offset:16384
  ds_read_b64_tr_b16 v[30:31], v8 offset:16896
  v_mfma_f32_32x32x16_bf16 v[108:123], v[40:43], v[204:207], v[108:123]
  ds_read_b64_tr_b16 v[32:33], v8 offset:18432
  ds_read_b64_tr_b16 v[34:35], v8 offset:18944
  s_waitcnt lgkmcnt(8)
  v_mfma_f32_32x32x16_bf16 v[108:123], v[44:47], v[208:211], v[108:123]
  ds_read_b64_tr_b16 v[36:37], v8 offset:20480
  ds_read_b64_tr_b16 v[38:39], v8 offset:20992
  s_mul_i32 s15, s18, 114688
  s_add_u32 s15, s15, 8388608
  s_lshl_b32 s53, s19, 11
  s_add_u32 s53, s53, s15
  s_lshl_b32 s54, s50, 11
  s_add_u32 s54, s54, s15

  v_mfma_f32_32x32x16_bf16 v[108:123], v[48:51], v[212:215], v[108:123]
  ds_read_b64_tr_b16 v[40:41], v8 offset:22528
  ds_read_b64_tr_b16 v[42:43], v8 offset:23040
  s_waitcnt lgkmcnt(8)
  v_mfma_f32_32x32x16_bf16 v[108:123], v[52:55], v[216:219], v[108:123]
  ds_read_b64_tr_b16 v[44:45], v8 offset:24576
  ds_read_b64_tr_b16 v[46:47], v8 offset:25088
  v_mfma_f32_32x32x16_bf16 v[108:123], v[56:59], v[220:223], v[108:123]
  ds_read_b64_tr_b16 v[48:49], v8 offset:26624
  ds_read_b64_tr_b16 v[50:51], v8 offset:27136
  s_waitcnt lgkmcnt(8)
  v_mfma_f32_32x32x16_bf16 v[108:123], v[28:31], v[224:227], v[108:123]
  ds_read_b64_tr_b16 v[52:53], v8 offset:28672
  ds_read_b64_tr_b16 v[54:55], v8 offset:29184
  v_mfma_f32_32x32x16_bf16 v[108:123], v[32:35], v[228:231], v[108:123]
  ds_read_b64_tr_b16 v[56:57], v8 offset:30720
  ds_read_b64_tr_b16 v[58:59], v8 offset:31232
  s_waitcnt lgkmcnt(8)
  v_mfma_f32_32x32x16_bf16 v[108:123], v[36:39], v[232:235], v[108:123]
  ds_read_b64_tr_b16 v[28:29], v9 offset:32768
  ds_read_b64_tr_b16 v[30:31], v9 offset:33280
  v_mfma_f32_32x32x16_bf16 v[108:123], v[40:43], v[236:239], v[108:123]
  ds_read_b64_tr_b16 v[32:33], v9 offset:34816
  ds_read_b64_tr_b16 v[34:35], v9 offset:35328
  s_waitcnt lgkmcnt(8)
  v_mfma_f32_32x32x16_bf16 v[108:123], v[44:47], v[240:243], v[108:123]
  ds_read_b64_tr_b16 v[36:37], v9 offset:36864
  ds_read_b64_tr_b16 v[38:39], v9 offset:37376
  v_mfma_f32_32x32x16_bf16 v[108:123], v[48:51], v[244:247], v[108:123]
  ds_read_b64_tr_b16 v[40:41], v9 offset:38912
  ds_read_b64_tr_b16 v[42:43], v9 offset:39424
  s_waitcnt lgkmcnt(8)
  v_mfma_f32_32x32x16_bf16 v[108:123], v[52:55], v[248:251], v[108:123]
  ds_read_b64_tr_b16 v[44:45], v9 offset:40960
  ds_read_b64_tr_b16 v[46:47], v9 offset:41472
  v_mfma_f32_32x32x16_bf16 v[108:123], v[56:59], v[252:255], v[108:123]
  ds_read_b64_tr_b16 v[48:49], v9 offset:43008
  ds_read_b64_tr_b16 v[50:51], v9 offset:43520
  s_waitcnt lgkmcnt(8)
  v_mfma_f32_32x32x16_bf16 v[92:107], v[28:31], v[128:131], 0
  ds_read_b64_tr_b16 v[52:53], v9 offset:45056
  ds_read_b64_tr_b16 v[54:55], v9 offset:45568
  v_mfma_f32_32x32x16_bf16 v[92:107], v[32:35], v[132:135], v[92:107]
  ds_read_b64_tr_b16 v[56:57], v9 offset:47104
  ds_read_b64_tr_b16 v[58:59], v9 offset:47616
  s_waitcnt lgkmcnt(8)
  v_mfma_f32_32x32x16_bf16 v[92:107], v[36:39], v[136:139], v[92:107]
  ds_read_b64_tr_b16 v[28:29], v9 offset:49152
  ds_read_b64_tr_b16 v[30:31], v9 offset:49664
  v_mfma_f32_32x32x16_bf16 v[92:107], v[40:43], v[140:143], v[92:107]
  ds_read_b64_tr_b16 v[32:33], v9 offset:51200
  ds_read_b64_tr_b16 v[34:35], v9 offset:51712
  s_mov_b32 s17, 0xbfb8aa3b
  v_mul_f32 v12, s17, v108
  v_mul_f32 v13, s17, v109
  s_waitcnt lgkmcnt(8)
  v_mfma_f32_32x32x16_bf16 v[92:107], v[44:47], v[144:147], v[92:107]
  ds_read_b64_tr_b16 v[36:37], v9 offset:53248
  ds_read_b64_tr_b16 v[38:39], v9 offset:53760
  v_exp_f32 v12, v12
  v_mul_f32 v14, s17, v110
  v_exp_f32 v13, v13
  v_mfma_f32_32x32x16_bf16 v[92:107], v[48:51], v[148:151], v[92:107]
  ds_read_b64_tr_b16 v[40:41], v9 offset:55296
  ds_read_b64_tr_b16 v[42:43], v9 offset:55808
  v_add_f32 v12, 1.0, v12
  v_mul_f32 v15, s17, v111
  v_exp_f32 v14, v14
  s_waitcnt lgkmcnt(8)
  v_mfma_f32_32x32x16_bf16 v[92:107], v[52:55], v[152:155], v[92:107]
  ds_read_b64_tr_b16 v[44:45], v9 offset:57344
  ds_read_b64_tr_b16 v[46:47], v9 offset:57856
  v_add_f32 v13, 1.0, v13
  v_rcp_f32 v12, v12
  v_mul_f32 v16, s17, v112
  v_mfma_f32_32x32x16_bf16 v[92:107], v[56:59], v[156:159], v[92:107]
  ds_read_b64_tr_b16 v[48:49], v9 offset:59392
  ds_read_b64_tr_b16 v[50:51], v9 offset:59904
  v_exp_f32 v15, v15
  v_add_f32 v14, 1.0, v14
  v_rcp_f32 v13, v13
  s_waitcnt lgkmcnt(8)
  v_mfma_f32_32x32x16_bf16 v[92:107], v[28:31], v[160:163], v[92:107]
  ds_read_b64_tr_b16 v[52:53], v9 offset:61440
  ds_read_b64_tr_b16 v[54:55], v9 offset:61952
  v_mul_f32 v108, v108, v12
  v_mul_f32 v17, s17, v113
  v_exp_f32 v16, v16
  v_mfma_f32_32x32x16_bf16 v[92:107], v[32:35], v[164:167], v[92:107]
  ds_read_b64_tr_b16 v[56:57], v9 offset:63488
  ds_read_b64_tr_b16 v[58:59], v9 offset:64000
  v_add_f32 v15, 1.0, v15
  v_rcp_f32 v14, v14
  v_mul_f32 v109, v109, v13
  s_waitcnt lgkmcnt(8)
  v_mfma_f32_32x32x16_bf16 v[92:107], v[36:39], v[168:171], v[92:107]
  v_add_u32 v9, 65536, v9
  ds_read_b64_tr_b16 v[28:29], v9 offset:0
  ds_read_b64_tr_b16 v[30:31], v9 offset:512
  v_mul_f32 v18, s17, v114
  v_exp_f32 v17, v17
  v_mfma_f32_32x32x16_bf16 v[92:107], v[40:43], v[172:175], v[92:107]
  ds_read_b64_tr_b16 v[32:33], v9 offset:2048
  ds_read_b64_tr_b16 v[34:35], v9 offset:2560
  v_add_f32 v16, 1.0, v16
  v_rcp_f32 v15, v15
  v_mul_f32 v110, v110, v14
  s_waitcnt lgkmcnt(8)
  v_mfma_f32_32x32x16_bf16 v[92:107], v[44:47], v[176:179], v[92:107]
  ds_read_b64_tr_b16 v[36:37], v9 offset:4096
  ds_read_b64_tr_b16 v[38:39], v9 offset:4608
  v_cvt_pk_bf16_f32 v108, v108, v109
  v_mul_f32 v19, s17, v115
  v_exp_f32 v18, v18
  v_mfma_f32_32x32x16_bf16 v[92:107], v[48:51], v[180:183], v[92:107]
  ds_read_b64_tr_b16 v[40:41], v9 offset:6144
  ds_read_b64_tr_b16 v[42:43], v9 offset:6656
  v_add_f32 v17, 1.0, v17
  v_rcp_f32 v16, v16
  v_mul_f32 v111, v111, v15
  s_waitcnt lgkmcnt(8)
  v_mfma_f32_32x32x16_bf16 v[92:107], v[52:55], v[184:187], v[92:107]
  ds_read_b64_tr_b16 v[44:45], v9 offset:8192
  ds_read_b64_tr_b16 v[46:47], v9 offset:8704
  v_mul_f32 v12, s17, v116
  v_exp_f32 v19, v19
  v_add_f32 v18, 1.0, v18
  v_mfma_f32_32x32x16_bf16 v[92:107], v[56:59], v[188:191], v[92:107]
  ds_read_b64_tr_b16 v[48:49], v9 offset:10240
  ds_read_b64_tr_b16 v[50:51], v9 offset:10752
  v_rcp_f32 v17, v17
  v_mul_f32 v112, v112, v16
  v_cvt_pk_bf16_f32 v109, v110, v111
  s_waitcnt lgkmcnt(8)
  v_mfma_f32_32x32x16_bf16 v[92:107], v[28:31], v[192:195], v[92:107]
  ds_read_b64_tr_b16 v[52:53], v9 offset:12288
  ds_read_b64_tr_b16 v[54:55], v9 offset:12800
  v_mul_f32 v13, s17, v117
  v_exp_f32 v12, v12
  v_add_f32 v19, 1.0, v19
  v_mfma_f32_32x32x16_bf16 v[92:107], v[32:35], v[196:199], v[92:107]
  ds_read_b64_tr_b16 v[56:57], v9 offset:14336
  ds_read_b64_tr_b16 v[58:59], v9 offset:14848
  v_rcp_f32 v18, v18
  v_mul_f32 v113, v113, v17
  v_mul_f32 v14, s17, v118
  s_waitcnt lgkmcnt(8)
  v_mfma_f32_32x32x16_bf16 v[92:107], v[36:39], v[200:203], v[92:107]
  ds_read_b64_tr_b16 v[28:29], v9 offset:16384
  ds_read_b64_tr_b16 v[30:31], v9 offset:16896
  v_exp_f32 v13, v13
  v_add_f32 v12, 1.0, v12
  v_mfma_f32_32x32x16_bf16 v[92:107], v[40:43], v[204:207], v[92:107]
  ds_read_b64_tr_b16 v[32:33], v9 offset:18432
  ds_read_b64_tr_b16 v[34:35], v9 offset:18944
  v_rcp_f32 v19, v19
  v_mul_f32 v114, v114, v18
  v_cvt_pk_bf16_f32 v110, v112, v113
  s_waitcnt lgkmcnt(8)
  v_mfma_f32_32x32x16_bf16 v[92:107], v[44:47], v[208:211], v[92:107]
  ds_read_b64_tr_b16 v[36:37], v9 offset:20480
  ds_read_b64_tr_b16 v[38:39], v9 offset:20992
  v_mul_f32 v15, s17, v119
  v_exp_f32 v14, v14
  v_add_f32 v13, 1.0, v13
  v_mfma_f32_32x32x16_bf16 v[92:107], v[48:51], v[212:215], v[92:107]
  ds_read_b64_tr_b16 v[40:41], v9 offset:22528
  ds_read_b64_tr_b16 v[42:43], v9 offset:23040
  ds_read_b64 v[20:21], v23 offset:0
  v_rcp_f32 v12, v12
  v_mul_f32 v115, v115, v19
  v_mul_f32 v16, s17, v120
  s_waitcnt lgkmcnt(9)
  v_mfma_f32_32x32x16_bf16 v[92:107], v[52:55], v[216:219], v[92:107]
  ds_read_b64_tr_b16 v[44:45], v9 offset:24576
  ds_read_b64_tr_b16 v[46:47], v9 offset:25088
  v_exp_f32 v15, v15
  v_add_f32 v14, 1.0, v14
  v_rcp_f32 v13, v13
  v_mfma_f32_32x32x16_bf16 v[92:107], v[56:59], v[220:223], v[92:107]
  ds_read_b64_tr_b16 v[48:49], v9 offset:26624
  ds_read_b64_tr_b16 v[50:51], v9 offset:27136
  v_mul_f32 v116, v116, v12
  v_cvt_pk_bf16_f32 v111, v114, v115
  v_mul_f32 v17, s17, v121
  s_waitcnt lgkmcnt(9)
  v_mfma_f32_32x32x16_bf16 v[92:107], v[28:31], v[224:227], v[92:107]
  ds_read_b64_tr_b16 v[52:53], v9 offset:28672
  ds_read_b64_tr_b16 v[54:55], v9 offset:29184
  v_exp_f32 v16, v16
  v_add_f32 v15, 1.0, v15
  v_rcp_f32 v14, v14
  v_mfma_f32_32x32x16_bf16 v[92:107], v[32:35], v[228:231], v[92:107]
  ds_read_b64_tr_b16 v[56:57], v9 offset:30720
  ds_read_b64_tr_b16 v[58:59], v9 offset:31232
  v_mul_f32 v117, v117, v13
  v_mul_f32 v18, s17, v122
  v_exp_f32 v17, v17
  s_cmp_lg_u32 s3, 0
  s_cbranch_scc1 L_codd
  s_waitcnt lgkmcnt(9)
  v_mfma_f32_32x32x16_bf16 v[92:107], v[36:39], v[232:235], v[92:107]
  s_waitcnt lgkmcnt(8)
  v_cmp_ne_u64 vcc, s[72:73], v[20:21]
  s_nop 0
  s_cbranch_vccnz L_wc15
L_wr15:
  v_subrev_u32 v8, 131072, v8
  ds_read_b64_tr_b16 v[28:29], v8 offset:0
  ds_read_b64_tr_b16 v[30:31], v8 offset:512
  v_add_f32 v16, 1.0, v16
  v_rcp_f32 v15, v15
  v_mfma_f32_32x32x16_bf16 v[92:107], v[40:43], v[236:239], v[92:107]
  ds_read_b64_tr_b16 v[32:33], v8 offset:2048
  ds_read_b64_tr_b16 v[34:35], v8 offset:2560
  v_mul_f32 v118, v118, v14
  v_cvt_pk_bf16_f32 v112, v116, v117
  v_mul_f32 v19, s17, v123
  s_waitcnt lgkmcnt(8)
  v_mfma_f32_32x32x16_bf16 v[92:107], v[44:47], v[240:243], v[92:107]
  ds_read_b64_tr_b16 v[36:37], v8 offset:4096
  ds_read_b64_tr_b16 v[38:39], v8 offset:4608
  v_exp_f32 v18, v18
  v_add_f32 v17, 1.0, v17
  v_rcp_f32 v16, v16
  v_mfma_f32_32x32x16_bf16 v[92:107], v[48:51], v[244:247], v[92:107]
  ds_read_b64_tr_b16 v[40:41], v8 offset:6144
  ds_read_b64_tr_b16 v[42:43], v8 offset:6656
  v_mul_f32 v119, v119, v15
  v_exp_f32 v19, v19
  v_add_f32 v18, 1.0, v18
  s_waitcnt lgkmcnt(8)
  v_mfma_f32_32x32x16_bf16 v[92:107], v[52:55], v[248:251], v[92:107]
  ds_read_b64_tr_b16 v[44:45], v8 offset:8192
  ds_read_b64_tr_b16 v[46:47], v8 offset:8704
  v_rcp_f32 v17, v17
  v_mul_f32 v120, v120, v16
  v_cvt_pk_bf16_f32 v113, v118, v119
  v_mfma_f32_32x32x16_bf16 v[92:107], v[56:59], v[252:255], v[92:107]
  ds_read_b64_tr_b16 v[48:49], v8 offset:10240
  ds_read_b64_tr_b16 v[50:51], v8 offset:10752
  s_mov_b64 exec, 1
  ds_write_b64 v22, v[124:125] offset:64
  s_mov_b64 exec, -1
  v_add_f32 v19, 1.0, v19
  v_rcp_f32 v18, v18
  v_mul_f32 v121, v121, v17
  s_waitcnt lgkmcnt(9)
  v_mfma_f32_32x32x16_bf16 v[60:75], v[28:31], v[128:131], 0
  ds_read_b64_tr_b16 v[52:53], v8 offset:12288
  ds_read_b64_tr_b16 v[54:55], v8 offset:12800
  v_rcp_f32 v19, v19
  v_mul_f32 v122, v122, v18
  v_cvt_pk_bf16_f32 v114, v120, v121
  v_mfma_f32_32x32x16_bf16 v[60:75], v[32:35], v[132:135], v[60:75]
  ds_read_b64_tr_b16 v[56:57], v8 offset:14336
  ds_read_b64_tr_b16 v[58:59], v8 offset:14848
  v_mul_f32 v123, v123, v19
  v_cvt_pk_bf16_f32 v115, v122, v123
  s_waitcnt lgkmcnt(9)
  v_mfma_f32_32x32x16_bf16 v[60:75], v[36:39], v[136:139], v[60:75]
  ds_read_b64_tr_b16 v[28:29], v8 offset:16384
  ds_read_b64_tr_b16 v[30:31], v8 offset:16896
  v_mfma_f32_32x32x16_bf16 v[60:75], v[40:43], v[140:143], v[60:75]
  ds_read_b64_tr_b16 v[32:33], v8 offset:18432
  ds_read_b64_tr_b16 v[34:35], v8 offset:18944
  s_mov_b32 s17, 0xbfb8aa3b
  v_mul_f32 v12, s17, v92
  v_mul_f32 v13, s17, v93
  s_waitcnt lgkmcnt(9)
  v_mfma_f32_32x32x16_bf16 v[60:75], v[44:47], v[144:147], v[60:75]
  ds_read_b64_tr_b16 v[36:37], v8 offset:20480
  ds_read_b64_tr_b16 v[38:39], v8 offset:20992
  v_exp_f32 v12, v12
  v_mul_f32 v14, s17, v94
  v_exp_f32 v13, v13
  v_mfma_f32_32x32x16_bf16 v[60:75], v[48:51], v[148:151], v[60:75]
  ds_read_b64_tr_b16 v[40:41], v8 offset:22528
  ds_read_b64_tr_b16 v[42:43], v8 offset:23040
  v_add_f32 v12, 1.0, v12
  v_mul_f32 v15, s17, v95
  v_exp_f32 v14, v14
  s_waitcnt lgkmcnt(8)
  v_mfma_f32_32x32x16_bf16 v[60:75], v[52:55], v[152:155], v[60:75]
  ds_read_b64_tr_b16 v[44:45], v8 offset:24576
  ds_read_b64_tr_b16 v[46:47], v8 offset:25088
  v_add_f32 v13, 1.0, v13
  v_rcp_f32 v12, v12
  v_mul_f32 v16, s17, v96
  v_mfma_f32_32x32x16_bf16 v[60:75], v[56:59], v[156:159], v[60:75]
  ds_read_b64_tr_b16 v[48:49], v8 offset:26624
  ds_read_b64_tr_b16 v[50:51], v8 offset:27136
  v_exp_f32 v15, v15
  v_add_f32 v14, 1.0, v14
  v_rcp_f32 v13, v13
  s_waitcnt lgkmcnt(8)
  v_mfma_f32_32x32x16_bf16 v[60:75], v[28:31], v[160:163], v[60:75]
  ds_read_b64_tr_b16 v[52:53], v8 offset:28672
  ds_read_b64_tr_b16 v[54:55], v8 offset:29184
  v_mul_f32 v92, v92, v12
  v_mul_f32 v17, s17, v97
  v_exp_f32 v16, v16
  v_mfma_f32_32x32x16_bf16 v[60:75], v[32:35], v[164:167], v[60:75]
  ds_read_b64_tr_b16 v[56:57], v8 offset:30720
  ds_read_b64_tr_b16 v[58:59], v8 offset:31232
  v_add_f32 v15, 1.0, v15
  v_rcp_f32 v14, v14
  v_mul_f32 v93, v93, v13
  s_waitcnt lgkmcnt(8)
  v_mfma_f32_32x32x16_bf16 v[60:75], v[36:39], v[168:171], v[60:75]
  ds_read_b64_tr_b16 v[28:29], v8 offset:32768
  ds_read_b64_tr_b16 v[30:31], v8 offset:33280
  v_mul_f32 v18, s17, v98
  v_exp_f32 v17, v17
  v_mfma_f32_32x32x16_bf16 v[60:75], v[40:43], v[172:175], v[60:75]
  ds_read_b64_tr_b16 v[32:33], v8 offset:34816
  ds_read_b64_tr_b16 v[34:35], v8 offset:35328
  v_add_f32 v16, 1.0, v16
  v_rcp_f32 v15, v15
  v_mul_f32 v94, v94, v14
  s_waitcnt lgkmcnt(8)
  v_mfma_f32_32x32x16_bf16 v[60:75], v[44:47], v[176:179], v[60:75]
  ds_read_b64_tr_b16 v[36:37], v8 offset:36864
  ds_read_b64_tr_b16 v[38:39], v8 offset:37376
  v_cvt_pk_bf16_f32 v116, v92, v93
  v_mul_f32 v19, s17, v99
  v_exp_f32 v18, v18
  v_mfma_f32_32x32x16_bf16 v[60:75], v[48:51], v[180:183], v[60:75]
  ds_read_b64_tr_b16 v[40:41], v8 offset:38912
  ds_read_b64_tr_b16 v[42:43], v8 offset:39424
  v_add_f32 v17, 1.0, v17
  v_rcp_f32 v16, v16
  v_mul_f32 v95, v95, v15
  s_waitcnt lgkmcnt(8)
  v_mfma_f32_32x32x16_bf16 v[60:75], v[52:55], v[184:187], v[60:75]
  ds_read_b64_tr_b16 v[44:45], v8 offset:40960
  ds_read_b64_tr_b16 v[46:47], v8 offset:41472
  v_mul_f32 v12, s17, v100
  v_exp_f32 v19, v19
  v_add_f32 v18, 1.0, v18
  v_mfma_f32_32x32x16_bf16 v[60:75], v[56:59], v[188:191], v[60:75]
  ds_read_b64_tr_b16 v[48:49], v8 offset:43008
  ds_read_b64_tr_b16 v[50:51], v8 offset:43520
  v_rcp_f32 v17, v17
  v_mul_f32 v96, v96, v16
  v_cvt_pk_bf16_f32 v117, v94, v95
  s_waitcnt lgkmcnt(8)
  v_mfma_f32_32x32x16_bf16 v[60:75], v[28:31], v[192:195], v[60:75]
  ds_read_b64_tr_b16 v[52:53], v8 offset:45056
  ds_read_b64_tr_b16 v[54:55], v8 offset:45568
  v_mul_f32 v13, s17, v101
  v_exp_f32 v12, v12
  v_add_f32 v19, 1.0, v19
  v_mfma_f32_32x32x16_bf16 v[60:75], v[32:35], v[196:199], v[60:75]
  ds_read_b64_tr_b16 v[56:57], v8 offset:47104
  ds_read_b64_tr_b16 v[58:59], v8 offset:47616
  v_rcp_f32 v18, v18
  v_mul_f32 v97, v97, v17
  v_mul_f32 v14, s17, v102
  s_waitcnt lgkmcnt(8)
  v_mfma_f32_32x32x16_bf16 v[60:75], v[36:39], v[200:203], v[60:75]
  ds_read_b64_tr_b16 v[28:29], v8 offset:49152
  ds_read_b64_tr_b16 v[30:31], v8 offset:49664
  v_exp_f32 v13, v13
  v_add_f32 v12, 1.0, v12
  v_mfma_f32_32x32x16_bf16 v[60:75], v[40:43], v[204:207], v[60:75]
  ds_read_b64_tr_b16 v[32:33], v8 offset:51200
  ds_read_b64_tr_b16 v[34:35], v8 offset:51712
  v_rcp_f32 v19, v19
  v_mul_f32 v98, v98, v18
  v_cvt_pk_bf16_f32 v118, v96, v97
  s_waitcnt lgkmcnt(8)
  v_mfma_f32_32x32x16_bf16 v[60:75], v[44:47], v[208:211], v[60:75]
  ds_read_b64_tr_b16 v[36:37], v8 offset:53248
  ds_read_b64_tr_b16 v[38:39], v8 offset:53760
  v_mul_f32 v15, s17, v103
  v_exp_f32 v14, v14
  v_add_f32 v13, 1.0, v13
  v_mfma_f32_32x32x16_bf16 v[60:75], v[48:51], v[212:215], v[60:75]
  ds_read_b64_tr_b16 v[40:41], v8 offset:55296
  ds_read_b64_tr_b16 v[42:43], v8 offset:55808
  v_rcp_f32 v12, v12
  v_mul_f32 v99, v99, v19
  v_mul_f32 v16, s17, v104
  s_waitcnt lgkmcnt(8)
  v_mfma_f32_32x32x16_bf16 v[60:75], v[52:55], v[216:219], v[60:75]
  ds_read_b64_tr_b16 v[44:45], v8 offset:57344
  ds_read_b64_tr_b16 v[46:47], v8 offset:57856
  v_exp_f32 v15, v15
  v_add_f32 v14, 1.0, v14
  v_rcp_f32 v13, v13
  v_mfma_f32_32x32x16_bf16 v[60:75], v[56:59], v[220:223], v[60:75]
  ds_read_b64_tr_b16 v[48:49], v8 offset:59392
  ds_read_b64_tr_b16 v[50:51], v8 offset:59904
  v_mul_f32 v100, v100, v12
  v_cvt_pk_bf16_f32 v119, v98, v99
  v_mul_f32 v17, s17, v105
  s_waitcnt lgkmcnt(8)
  v_mfma_f32_32x32x16_bf16 v[60:75], v[28:31], v[224:227], v[60:75]
  ds_read_b64_tr_b16 v[52:53], v8 offset:61440
  ds_read_b64_tr_b16 v[54:55], v8 offset:61952
  v_exp_f32 v16, v16
  v_add_f32 v15, 1.0, v15
  v_rcp_f32 v14, v14
  v_mfma_f32_32x32x16_bf16 v[60:75], v[32:35], v[228:231], v[60:75]
  ds_read_b64_tr_b16 v[56:57], v8 offset:63488
  ds_read_b64_tr_b16 v[58:59], v8 offset:64000
  v_mul_f32 v101, v101, v13
  v_mul_f32 v18, s17, v106
  v_exp_f32 v17, v17
  s_waitcnt lgkmcnt(8)
  v_mfma_f32_32x32x16_bf16 v[60:75], v[36:39], v[232:235], v[60:75]
  v_subrev_u32 v9, 131072, v9
  ds_read_b64_tr_b16 v[28:29], v9 offset:0
  ds_read_b64_tr_b16 v[30:31], v9 offset:512
  v_add_f32 v16, 1.0, v16
  v_rcp_f32 v15, v15
  v_mfma_f32_32x32x16_bf16 v[60:75], v[40:43], v[236:239], v[60:75]
  ds_read_b64_tr_b16 v[32:33], v9 offset:2048
  ds_read_b64_tr_b16 v[34:35], v9 offset:2560
  v_mul_f32 v102, v102, v14
  v_cvt_pk_bf16_f32 v120, v100, v101
  v_mul_f32 v19, s17, v107
  s_waitcnt lgkmcnt(8)
  v_mfma_f32_32x32x16_bf16 v[60:75], v[44:47], v[240:243], v[60:75]
  ds_read_b64_tr_b16 v[36:37], v9 offset:4096
  ds_read_b64_tr_b16 v[38:39], v9 offset:4608
  v_exp_f32 v18, v18
  v_add_f32 v17, 1.0, v17
  v_rcp_f32 v16, v16
  v_mfma_f32_32x32x16_bf16 v[60:75], v[48:51], v[244:247], v[60:75]
  ds_read_b64_tr_b16 v[40:41], v9 offset:6144
  ds_read_b64_tr_b16 v[42:43], v9 offset:6656
  v_mul_f32 v103, v103, v15
  v_exp_f32 v19, v19
  v_add_f32 v18, 1.0, v18
  s_waitcnt lgkmcnt(8)
  v_mfma_f32_32x32x16_bf16 v[60:75], v[52:55], v[248:251], v[60:75]
  ds_read_b64_tr_b16 v[44:45], v9 offset:8192
  ds_read_b64_tr_b16 v[46:47], v9 offset:8704
  v_rcp_f32 v17, v17
  v_mul_f32 v104, v104, v16
  v_cvt_pk_bf16_f32 v121, v102, v103
  v_mfma_f32_32x32x16_bf16 v[60:75], v[56:59], v[252:255], v[60:75]
  ds_read_b64_tr_b16 v[48:49], v9 offset:10240
  ds_read_b64_tr_b16 v[50:51], v9 offset:10752
  v_add_f32 v19, 1.0, v19
  v_rcp_f32 v18, v18
  v_mul_f32 v105, v105, v17
  s_waitcnt lgkmcnt(8)
  v_mfma_f32_32x32x16_bf16 v[76:91], v[28:31], v[128:131], 0
  ds_read_b64_tr_b16 v[52:53], v9 offset:12288
  ds_read_b64_tr_b16 v[54:55], v9 offset:12800
  v_rcp_f32 v19, v19
  v_mul_f32 v106, v106, v18
  v_cvt_pk_bf16_f32 v122, v104, v105
  v_mfma_f32_32x32x16_bf16 v[76:91], v[32:35], v[132:135], v[76:91]
  ds_read_b64_tr_b16 v[56:57], v9 offset:14336
  ds_read_b64_tr_b16 v[58:59], v9 offset:14848
  v_mul_f32 v107, v107, v19
  v_cvt_pk_bf16_f32 v123, v106, v107
  s_waitcnt lgkmcnt(8)
  v_mfma_f32_32x32x16_bf16 v[76:91], v[36:39], v[136:139], v[76:91]
  ds_read_b64_tr_b16 v[28:29], v9 offset:16384
  ds_read_b64_tr_b16 v[30:31], v9 offset:16896
  v_mfma_f32_32x32x16_bf16 v[76:91], v[40:43], v[140:143], v[76:91]
  ds_read_b64_tr_b16 v[32:33], v9 offset:18432
  ds_read_b64_tr_b16 v[34:35], v9 offset:18944
  s_mov_b32 s17, 0xbfb8aa3b
  v_mul_f32 v12, s17, v60
  v_mul_f32 v13, s17, v61
  v_exp_f32 v12, v12
  s_waitcnt lgkmcnt(8)
  v_mfma_f32_32x32x16_bf16 v[76:91], v[44:47], v[144:147], v[76:91]
  ds_read_b64_tr_b16 v[36:37], v9 offset:20480
  ds_read_b64_tr_b16 v[38:39], v9 offset:20992
  v_mul_f32 v14, s17, v62
  v_exp_f32 v13, v13
  v_add_f32 v12, 1.0, v12
  v_mfma_f32_32x32x16_bf16 v[76:91], v[48:51], v[148:151], v[76:91]
  ds_read_b64_tr_b16 v[40:41], v9 offset:22528
  ds_read_b64_tr_b16 v[42:43], v9 offset:23040
  v_mul_f32 v15, s17, v63
  v_exp_f32 v14, v14
  v_add_f32 v13, 1.0, v13
  s_waitcnt lgkmcnt(8)
  v_mfma_f32_32x32x16_bf16 v[76:91], v[52:55], v[152:155], v[76:91]
  ds_read_b64_tr_b16 v[44:45], v9 offset:24576
  ds_read_b64_tr_b16 v[46:47], v9 offset:25088
  v_rcp_f32 v12, v12
  v_mul_f32 v16, s17, v64
  v_exp_f32 v15, v15
  v_mfma_f32_32x32x16_bf16 v[76:91], v[56:59], v[156:159], v[76:91]
  ds_read_b64_tr_b16 v[48:49], v9 offset:26624
  ds_read_b64_tr_b16 v[50:51], v9 offset:27136
  v_add_f32 v14, 1.0, v14
  v_rcp_f32 v13, v13
  v_mul_f32 v60, v60, v12
  s_waitcnt lgkmcnt(8)
  v_mfma_f32_32x32x16_bf16 v[76:91], v[28:31], v[160:163], v[76:91]
  ds_read_b64_tr_b16 v[52:53], v9 offset:28672
  ds_read_b64_tr_b16 v[54:55], v9 offset:29184
  v_mul_f32 v17, s17, v65
  v_exp_f32 v16, v16
  v_add_f32 v15, 1.0, v15
  v_mfma_f32_32x32x16_bf16 v[76:91], v[32:35], v[164:167], v[76:91]
  ds_read_b64_tr_b16 v[56:57], v9 offset:30720
  ds_read_b64_tr_b16 v[58:59], v9 offset:31232
  v_rcp_f32 v14, v14
  v_mul_f32 v61, v61, v13
  v_mul_f32 v18, s17, v66
  s_waitcnt lgkmcnt(8)
  v_mfma_f32_32x32x16_bf16 v[76:91], v[36:39], v[168:171], v[76:91]
  ds_read_b64_tr_b16 v[28:29], v9 offset:32768
  ds_read_b64_tr_b16 v[30:31], v9 offset:33280
  v_exp_f32 v17, v17
  v_add_f32 v16, 1.0, v16
  v_rcp_f32 v15, v15
  v_mfma_f32_32x32x16_bf16 v[76:91], v[40:43], v[172:175], v[76:91]
  ds_read_b64_tr_b16 v[32:33], v9 offset:34816
  ds_read_b64_tr_b16 v[34:35], v9 offset:35328
  v_mul_f32 v62, v62, v14
  v_cvt_pk_bf16_f32 v128, v60, v61
  v_mul_f32 v19, s17, v67
  s_waitcnt lgkmcnt(8)
  v_mfma_f32_32x32x16_bf16 v[76:91], v[44:47], v[176:179], v[76:91]
  ds_read_b64_tr_b16 v[36:37], v9 offset:36864
  ds_read_b64_tr_b16 v[38:39], v9 offset:37376
  v_exp_f32 v18, v18
  v_add_f32 v17, 1.0, v17
  v_rcp_f32 v16, v16
  v_mfma_f32_32x32x16_bf16 v[76:91], v[48:51], v[180:183], v[76:91]
  ds_read_b64_tr_b16 v[40:41], v9 offset:38912
  ds_read_b64_tr_b16 v[42:43], v9 offset:39424
  v_mul_f32 v63, v63, v15
  v_mul_f32 v12, s17, v68
  v_exp_f32 v19, v19
  s_waitcnt lgkmcnt(8)
  v_mfma_f32_32x32x16_bf16 v[76:91], v[52:55], v[184:187], v[76:91]
  ds_read_b64_tr_b16 v[44:45], v9 offset:40960
  ds_read_b64_tr_b16 v[46:47], v9 offset:41472
  v_add_f32 v18, 1.0, v18
  v_rcp_f32 v17, v17
  v_mul_f32 v64, v64, v16
  v_mfma_f32_32x32x16_bf16 v[76:91], v[56:59], v[188:191], v[76:91]
  ds_read_b64_tr_b16 v[48:49], v9 offset:43008
  ds_read_b64_tr_b16 v[50:51], v9 offset:43520
  v_cvt_pk_bf16_f32 v129, v62, v63
  v_mul_f32 v13, s17, v69
  v_exp_f32 v12, v12
  s_waitcnt lgkmcnt(8)
  v_mfma_f32_32x32x16_bf16 v[76:91], v[28:31], v[192:195], v[76:91]
  ds_read_b64_tr_b16 v[52:53], v9 offset:45056
  ds_read_b64_tr_b16 v[54:55], v9 offset:45568
  v_add_f32 v19, 1.0, v19
  v_rcp_f32 v18, v18
  v_mul_f32 v65, v65, v17
  v_mfma_f32_32x32x16_bf16 v[76:91], v[32:35], v[196:199], v[76:91]
  ds_read_b64_tr_b16 v[56:57], v9 offset:47104
  ds_read_b64_tr_b16 v[58:59], v9 offset:47616
  v_mul_f32 v14, s17, v70
  v_exp_f32 v13, v13
  v_add_f32 v12, 1.0, v12
  v_rcp_f32 v19, v19
  s_waitcnt lgkmcnt(8)
  v_mfma_f32_32x32x16_bf16 v[76:91], v[36:39], v[200:203], v[76:91]
  ds_read_b64_tr_b16 v[28:29], v9 offset:49152
  ds_read_b64_tr_b16 v[30:31], v9 offset:49664
  v_mul_f32 v66, v66, v18
  v_cvt_pk_bf16_f32 v130, v64, v65
  v_mul_f32 v15, s17, v71
  v_mfma_f32_32x32x16_bf16 v[76:91], v[40:43], v[204:207], v[76:91]
  ds_read_b64_tr_b16 v[32:33], v9 offset:51200
  ds_read_b64_tr_b16 v[34:35], v9 offset:51712
  v_exp_f32 v14, v14
  v_add_f32 v13, 1.0, v13
  v_rcp_f32 v12, v12
  s_waitcnt lgkmcnt(8)
  v_mfma_f32_32x32x16_bf16 v[76:91], v[44:47], v[208:211], v[76:91]
  ds_read_b64_tr_b16 v[36:37], v9 offset:53248
  ds_read_b64_tr_b16 v[38:39], v9 offset:53760
  v_mul_f32 v67, v67, v19
  v_mul_f32 v16, s17, v72
  v_exp_f32 v15, v15
  v_mfma_f32_32x32x16_bf16 v[76:91], v[48:51], v[212:215], v[76:91]
  ds_read_b64_tr_b16 v[40:41], v9 offset:55296
  ds_read_b64_tr_b16 v[42:43], v9 offset:55808
  v_add_f32 v14, 1.0, v14
  v_rcp_f32 v13, v13
  v_mul_f32 v68, v68, v12
  s_waitcnt lgkmcnt(8)
  v_mfma_f32_32x32x16_bf16 v[76:91], v[52:55], v[216:219], v[76:91]
  ds_read_b64_tr_b16 v[44:45], v9 offset:57344
  ds_read_b64_tr_b16 v[46:47], v9 offset:57856
  v_cvt_pk_bf16_f32 v131, v66, v67
  v_mul_f32 v17, s17, v73
  v_exp_f32 v16, v16
  v_mfma_f32_32x32x16_bf16 v[76:91], v[56:59], v[220:223], v[76:91]
  ds_read_b64_tr_b16 v[48:49], v9 offset:59392
  ds_read_b64_tr_b16 v[50:51], v9 offset:59904
  v_add_f32 v15, 1.0, v15
  v_rcp_f32 v14, v14
  v_mul_f32 v69, v69, v13
  s_waitcnt lgkmcnt(8)
  v_mfma_f32_32x32x16_bf16 v[76:91], v[28:31], v[224:227], v[76:91]
  ds_read_b64_tr_b16 v[52:53], v9 offset:61440
  ds_read_b64_tr_b16 v[54:55], v9 offset:61952
  v_mul_f32 v18, s17, v74
  v_exp_f32 v17, v17
  v_add_f32 v16, 1.0, v16
  v_mfma_f32_32x32x16_bf16 v[76:91], v[32:35], v[228:231], v[76:91]
  ds_read_b64_tr_b16 v[56:57], v9 offset:63488
  ds_read_b64_tr_b16 v[58:59], v9 offset:64000
  v_rcp_f32 v15, v15
  v_mul_f32 v70, v70, v14
  v_cvt_pk_bf16_f32 v132, v68, v69
  s_waitcnt lgkmcnt(8)
  v_mfma_f32_32x32x16_bf16 v[76:91], v[36:39], v[232:235], v[76:91]
  v_mul_f32 v19, s17, v75
  v_exp_f32 v18, v18
  v_add_f32 v17, 1.0, v17
  v_mfma_f32_32x32x16_bf16 v[76:91], v[40:43], v[236:239], v[76:91]
  v_rcp_f32 v16, v16
  v_mul_f32 v71, v71, v15
  v_exp_f32 v19, v19
  s_waitcnt lgkmcnt(4)
  v_mfma_f32_32x32x16_bf16 v[76:91], v[44:47], v[240:243], v[76:91]
  v_add_f32 v18, 1.0, v18
  v_rcp_f32 v17, v17
  v_mul_f32 v72, v72, v16
  v_mfma_f32_32x32x16_bf16 v[76:91], v[48:51], v[244:247], v[76:91]
  v_cvt_pk_bf16_f32 v133, v70, v71
  v_add_f32 v19, 1.0, v19
  v_rcp_f32 v18, v18
  s_waitcnt lgkmcnt(0)
  v_mfma_f32_32x32x16_bf16 v[76:91], v[52:55], v[248:251], v[76:91]
  v_mul_f32 v73, v73, v17
  v_rcp_f32 v19, v19
  v_mul_f32 v74, v74, v18
  v_mfma_f32_32x32x16_bf16 v[76:91], v[56:59], v[252:255], v[76:91]
  s_mov_b64 exec, 1
  ds_write_b64 v22, v[124:125] offset:192
  s_mov_b64 exec, -1
  ds_read_b64 v[202:203], v23 offset:128
  v_cvt_pk_bf16_f32 v134, v72, v73
  v_mul_f32 v75, v75, v19
  v_cvt_pk_bf16_f32 v135, v74, v75
  s_and_b32 s56, s2, 7
  s_lshl_b32 s56, s56, 2
  s_lshr_b32 s15, s2, 3
  s_and_b32 s16, s15, 3
  s_add_u32 s56, s56, s16
  s_lshr_b32 s48, s15, 2
  s_lshl_b32 s57, s48, 3
  s_add_u32 s57, s57, s12
  s_lshl_b32 s58, s56, 17
  s_add_u32 s58, s58, 2097152

  s_nop 0
  s_mov_b32 s17, 0xbfb8aa3b
  v_mul_f32 v12, s17, v76
  v_mul_f32 v13, s17, v77
  v_exp_f32 v12, v12
  v_mul_f32 v14, s17, v78
  v_exp_f32 v13, v13
  v_add_f32 v12, 1.0, v12
  v_mul_f32 v15, s17, v79
  v_exp_f32 v14, v14
  v_add_f32 v13, 1.0, v13
  v_rcp_f32 v12, v12
  v_mul_f32 v16, s17, v80
  v_exp_f32 v15, v15
  v_add_f32 v14, 1.0, v14
  v_rcp_f32 v13, v13
  v_mul_f32 v76, v76, v12
  v_mul_f32 v17, s17, v81
  v_exp_f32 v16, v16
  v_add_f32 v15, 1.0, v15
  v_rcp_f32 v14, v14
  v_mul_f32 v77, v77, v13
  v_mul_f32 v18, s17, v82
  v_exp_f32 v17, v17
  v_add_f32 v16, 1.0, v16
  v_rcp_f32 v15, v15
  v_mul_f32 v78, v78, v14
  v_cvt_pk_bf16_f32 v136, v76, v77
  v_mul_f32 v19, s17, v83
  v_exp_f32 v18, v18
  v_add_f32 v17, 1.0, v17
  v_rcp_f32 v16, v16
  v_mul_f32 v79, v79, v15
  v_mul_f32 v12, s17, v84
  v_exp_f32 v19, v19
  v_add_f32 v18, 1.0, v18
  v_rcp_f32 v17, v17
  v_mul_f32 v80, v80, v16
  v_cvt_pk_bf16_f32 v137, v78, v79
  v_mul_f32 v13, s17, v85
  v_exp_f32 v12, v12
  v_add_f32 v19, 1.0, v19
  v_rcp_f32 v18, v18
  v_mul_f32 v81, v81, v17
  v_mul_f32 v14, s17, v86
  v_exp_f32 v13, v13
  v_add_f32 v12, 1.0, v12
  v_rcp_f32 v19, v19
  v_mul_f32 v82, v82, v18
  v_cvt_pk_bf16_f32 v138, v80, v81
  v_mul_f32 v15, s17, v87
  v_exp_f32 v14, v14
  v_add_f32 v13, 1.0, v13
  v_rcp_f32 v12, v12
  v_mul_f32 v83, v83, v19
  v_mul_f32 v16, s17, v88
  v_exp_f32 v15, v15
  v_add_f32 v14, 1.0, v14
  v_rcp_f32 v13, v13
  v_mul_f32 v84, v84, v12
  v_cvt_pk_bf16_f32 v139, v82, v83
  v_mul_f32 v17, s17, v89
  v_exp_f32 v16, v16
  v_add_f32 v15, 1.0, v15
  v_rcp_f32 v14, v14
  v_mul_f32 v85, v85, v13
  v_mul_f32 v18, s17, v90
  v_exp_f32 v17, v17
  v_add_f32 v16, 1.0, v16
  v_rcp_f32 v15, v15
  v_mul_f32 v86, v86, v14
  v_cvt_pk_bf16_f32 v140, v84, v85
  v_mul_f32 v19, s17, v91
  v_exp_f32 v18, v18
  v_add_f32 v17, 1.0, v17
  v_rcp_f32 v16, v16
  v_mul_f32 v87, v87, v15
  v_exp_f32 v19, v19
  v_add_f32 v18, 1.0, v18
  v_rcp_f32 v17, v17
  v_mul_f32 v88, v88, v16
  v_cvt_pk_bf16_f32 v141, v86, v87
  v_add_f32 v19, 1.0, v19
  v_rcp_f32 v18, v18
  v_mul_f32 v89, v89, v17
  v_rcp_f32 v19, v19
  v_mul_f32 v90, v90, v18
  v_cvt_pk_bf16_f32 v142, v88, v89
  v_mul_f32 v91, v91, v19
  v_cvt_pk_bf16_f32 v143, v90, v91
  s_branch L_attC
L_codd:
  s_waitcnt lgkmcnt(9)
  v_mfma_f32_32x32x16_bf16 v[92:107], v[36:39], v[232:235], v[92:107]
  s_waitcnt lgkmcnt(8)
  v_cmp_ne_u64 vcc, s[72:73], v[20:21]
  s_nop 0
  s_cbranch_vccnz L_wc18
L_wr18:
  v_subrev_u32 v10, 65536, v10
  ds_read_b64_tr_b16 v[28:29], v10 offset:0
  ds_read_b64_tr_b16 v[30:31], v10 offset:256
  v_add_f32 v16, 1.0, v16
  v_rcp_f32 v15, v15
  v_mfma_f32_32x32x16_bf16 v[92:107], v[40:43], v[236:239], v[92:107]
  ds_read_b64_tr_b16 v[32:33], v10 offset:1024
  ds_read_b64_tr_b16 v[34:35], v10 offset:1280
  v_mul_f32 v118, v118, v14
  v_cvt_pk_bf16_f32 v112, v116, v117
  v_mul_f32 v19, s17, v123
  s_waitcnt lgkmcnt(8)
  v_mfma_f32_32x32x16_bf16 v[92:107], v[44:47], v[240:243], v[92:107]
  ds_read_b64_tr_b16 v[36:37], v10 offset:2048
  ds_read_b64_tr_b16 v[38:39], v10 offset:2304
  v_exp_f32 v18, v18
  v_add_f32 v17, 1.0, v17
  v_rcp_f32 v16, v16
  v_mfma_f32_32x32x16_bf16 v[92:107], v[48:51], v[244:247], v[92:107]
  ds_read_b64_tr_b16 v[40:41], v10 offset:3072
  ds_read_b64_tr_b16 v[42:43], v10 offset:3328
  v_mul_f32 v119, v119, v15
  v_exp_f32 v19, v19
  v_add_f32 v18, 1.0, v18
  s_waitcnt lgkmcnt(8)
  v_mfma_f32_32x32x16_bf16 v[92:107], v[52:55], v[248:251], v[92:107]
  ds_read_b64_tr_b16 v[44:45], v10 offset:4096
  ds_read_b64_tr_b16 v[46:47], v10 offset:4352
  v_rcp_f32 v17, v17
  v_mul_f32 v120, v120, v16
  v_cvt_pk_bf16_f32 v113, v118, v119
  v_mfma_f32_32x32x16_bf16 v[92:107], v[56:59], v[252:255], v[92:107]
  ds_read_b64_tr_b16 v[48:49], v10 offset:5120
  ds_read_b64_tr_b16 v[50:51], v10 offset:5376
  s_mov_b64 exec, 1
  ds_write_b64 v22, v[124:125] offset:64
  s_mov_b64 exec, -1
  v_add_f32 v19, 1.0, v19
  v_rcp_f32 v18, v18
  v_mul_f32 v121, v121, v17
  s_waitcnt lgkmcnt(9)
  v_mfma_f32_32x32x16_bf16 v[60:75], v[28:31], v[128:131], 0
  ds_read_b64_tr_b16 v[52:53], v10 offset:6144
  ds_read_b64_tr_b16 v[54:55], v10 offset:6400
  v_rcp_f32 v19, v19
  v_mul_f32 v122, v122, v18
  v_cvt_pk_bf16_f32 v114, v120, v121
  v_mfma_f32_32x32x16_bf16 v[60:75], v[32:35], v[132:135], v[60:75]
  ds_read_b64_tr_b16 v[56:57], v10 offset:7168
  ds_read_b64_tr_b16 v[58:59], v10 offset:7424
  v_mul_f32 v123, v123, v19
  v_cvt_pk_bf16_f32 v115, v122, v123
  s_waitcnt lgkmcnt(9)
  v_mfma_f32_32x32x16_bf16 v[60:75], v[36:39], v[136:139], v[60:75]
  ds_read_b64_tr_b16 v[28:29], v10 offset:8192
  ds_read_b64_tr_b16 v[30:31], v10 offset:8448
  v_mfma_f32_32x32x16_bf16 v[60:75], v[40:43], v[140:143], v[60:75]
  ds_read_b64_tr_b16 v[32:33], v10 offset:9216
  ds_read_b64_tr_b16 v[34:35], v10 offset:9472
  s_mov_b32 s17, 0xbfb8aa3b
  v_mul_f32 v12, s17, v92
  v_mul_f32 v13, s17, v93
  v_exp_f32 v12, v12
  s_waitcnt lgkmcnt(9)
  v_mfma_f32_32x32x16_bf16 v[60:75], v[44:47], v[144:147], v[60:75]
  ds_read_b64_tr_b16 v[36:37], v10 offset:10240
  ds_read_b64_tr_b16 v[38:39], v10 offset:10496
  v_mul_f32 v14, s17, v94
  v_exp_f32 v13, v13
  v_add_f32 v12, 1.0, v12
  v_mfma_f32_32x32x16_bf16 v[60:75], v[48:51], v[148:151], v[60:75]
  ds_read_b64_tr_b16 v[40:41], v10 offset:11264
  ds_read_b64_tr_b16 v[42:43], v10 offset:11520
  v_mul_f32 v15, s17, v95
  v_exp_f32 v14, v14
  v_add_f32 v13, 1.0, v13
  s_waitcnt lgkmcnt(8)
  v_mfma_f32_32x32x16_bf16 v[60:75], v[52:55], v[152:155], v[60:75]
  ds_read_b64_tr_b16 v[44:45], v10 offset:12288
  ds_read_b64_tr_b16 v[46:47], v10 offset:12544
  v_rcp_f32 v12, v12
  v_mul_f32 v16, s17, v96
  v_exp_f32 v15, v15
  v_mfma_f32_32x32x16_bf16 v[60:75], v[56:59], v[156:159], v[60:75]
  ds_read_b64_tr_b16 v[48:49], v10 offset:13312
  ds_read_b64_tr_b16 v[50:51], v10 offset:13568
  v_add_f32 v14, 1.0, v14
  v_rcp_f32 v13, v13
  v_mul_f32 v92, v92, v12
  s_waitcnt lgkmcnt(8)
  v_mfma_f32_32x32x16_bf16 v[60:75], v[28:31], v[160:163], v[60:75]
  ds_read_b64_tr_b16 v[52:53], v10 offset:14336
  ds_read_b64_tr_b16 v[54:55], v10 offset:14592
  v_mul_f32 v17, s17, v97
  v_exp_f32 v16, v16
  v_add_f32 v15, 1.0, v15
  v_mfma_f32_32x32x16_bf16 v[60:75], v[32:35], v[164:167], v[60:75]
  ds_read_b64_tr_b16 v[56:57], v10 offset:15360
  ds_read_b64_tr_b16 v[58:59], v10 offset:15616
  v_rcp_f32 v14, v14
  v_mul_f32 v93, v93, v13
  v_mul_f32 v18, s17, v98
  s_waitcnt lgkmcnt(8)
  v_mfma_f32_32x32x16_bf16 v[60:75], v[36:39], v[168:171], v[60:75]
  ds_read_b64_tr_b16 v[28:29], v10 offset:16384
  ds_read_b64_tr_b16 v[30:31], v10 offset:16640
  v_exp_f32 v17, v17
  v_add_f32 v16, 1.0, v16
  v_rcp_f32 v15, v15
  v_mfma_f32_32x32x16_bf16 v[60:75], v[40:43], v[172:175], v[60:75]
  ds_read_b64_tr_b16 v[32:33], v10 offset:17408
  ds_read_b64_tr_b16 v[34:35], v10 offset:17664
  v_mul_f32 v94, v94, v14
  v_cvt_pk_bf16_f32 v116, v92, v93
  v_mul_f32 v19, s17, v99
  s_waitcnt lgkmcnt(8)
  v_mfma_f32_32x32x16_bf16 v[60:75], v[44:47], v[176:179], v[60:75]
  ds_read_b64_tr_b16 v[36:37], v10 offset:18432
  ds_read_b64_tr_b16 v[38:39], v10 offset:18688
  v_exp_f32 v18, v18
  v_add_f32 v17, 1.0, v17
  v_rcp_f32 v16, v16
  v_mfma_f32_32x32x16_bf16 v[60:75], v[48:51], v[180:183], v[60:75]
  ds_read_b64_tr_b16 v[40:41], v10 offset:19456
  ds_read_b64_tr_b16 v[42:43], v10 offset:19712
  v_mul_f32 v95, v95, v15
  v_mul_f32 v12, s17, v100
  v_exp_f32 v19, v19
  s_waitcnt lgkmcnt(8)
  v_mfma_f32_32x32x16_bf16 v[60:75], v[52:55], v[184:187], v[60:75]
  ds_read_b64_tr_b16 v[44:45], v10 offset:20480
  ds_read_b64_tr_b16 v[46:47], v10 offset:20736
  v_add_f32 v18, 1.0, v18
  v_rcp_f32 v17, v17
  v_mul_f32 v96, v96, v16
  v_mfma_f32_32x32x16_bf16 v[60:75], v[56:59], v[188:191], v[60:75]
  ds_read_b64_tr_b16 v[48:49], v10 offset:21504
  ds_read_b64_tr_b16 v[50:51], v10 offset:21760
  v_cvt_pk_bf16_f32 v117, v94, v95
  v_mul_f32 v13, s17, v101
  v_exp_f32 v12, v12
  s_waitcnt lgkmcnt(8)
  v_mfma_f32_32x32x16_bf16 v[60:75], v[28:31], v[192:195], v[60:75]
  ds_read_b64_tr_b16 v[52:53], v10 offset:22528
  ds_read_b64_tr_b16 v[54:55], v10 offset:22784
  v_add_f32 v19, 1.0, v19
  v_rcp_f32 v18, v18
  v_mul_f32 v97, v97, v17
  v_mfma_f32_32x32x16_bf16 v[60:75], v[32:35], v[196:199], v[60:75]
  ds_read_b64_tr_b16 v[56:57], v10 offset:23552
  ds_read_b64_tr_b16 v[58:59], v10 offset:23808
  v_mul_f32 v14, s17, v102
  v_exp_f32 v13, v13
  v_add_f32 v12, 1.0, v12
  v_rcp_f32 v19, v19
  s_waitcnt lgkmcnt(8)
  v_mfma_f32_32x32x16_bf16 v[60:75], v[36:39], v[200:203], v[60:75]
  ds_read_b64_tr_b16 v[28:29], v10 offset:24576
  ds_read_b64_tr_b16 v[30:31], v10 offset:24832
  v_mul_f32 v98, v98, v18
  v_cvt_pk_bf16_f32 v118, v96, v97
  v_mul_f32 v15, s17, v103
  v_mfma_f32_32x32x16_bf16 v[60:75], v[40:43], v[204:207], v[60:75]
  ds_read_b64_tr_b16 v[32:33], v10 offset:25600
  ds_read_b64_tr_b16 v[34:35], v10 offset:25856
  v_exp_f32 v14, v14
  v_add_f32 v13, 1.0, v13
  v_rcp_f32 v12, v12
  s_waitcnt lgkmcnt(8)
  v_mfma_f32_32x32x16_bf16 v[60:75], v[44:47], v[208:211], v[60:75]
  ds_read_b64_tr_b16 v[36:37], v10 offset:26624
  ds_read_b64_tr_b16 v[38:39], v10 offset:26880
  v_mul_f32 v99, v99, v19
  v_mul_f32 v16, s17, v104
  v_exp_f32 v15, v15
  v_mfma_f32_32x32x16_bf16 v[60:75], v[48:51], v[212:215], v[60:75]
  ds_read_b64_tr_b16 v[40:41], v10 offset:27648
  ds_read_b64_tr_b16 v[42:43], v10 offset:27904
  v_add_f32 v14, 1.0, v14
  v_rcp_f32 v13, v13
  v_mul_f32 v100, v100, v12
  s_waitcnt lgkmcnt(8)
  v_mfma_f32_32x32x16_bf16 v[60:75], v[52:55], v[216:219], v[60:75]
  ds_read_b64_tr_b16 v[44:45], v10 offset:28672
  ds_read_b64_tr_b16 v[46:47], v10 offset:28928
  v_cvt_pk_bf16_f32 v119, v98, v99
  v_mul_f32 v17, s17, v105
  v_exp_f32 v16, v16
  v_mfma_f32_32x32x16_bf16 v[60:75], v[56:59], v[220:223], v[60:75]
  ds_read_b64_tr_b16 v[48:49], v10 offset:29696
  ds_read_b64_tr_b16 v[50:51], v10 offset:29952
  v_add_f32 v15, 1.0, v15
  v_rcp_f32 v14, v14
  v_mul_f32 v101, v101, v13
  s_waitcnt lgkmcnt(8)
  v_mfma_f32_32x32x16_bf16 v[60:75], v[28:31], v[224:227], v[60:75]
  ds_read_b64_tr_b16 v[52:53], v10 offset:30720
  ds_read_b64_tr_b16 v[54:55], v10 offset:30976
  v_mul_f32 v18, s17, v106
  v_exp_f32 v17, v17
  v_add_f32 v16, 1.0, v16
  v_mfma_f32_32x32x16_bf16 v[60:75], v[32:35], v[228:231], v[60:75]
  ds_read_b64_tr_b16 v[56:57], v10 offset:31744
  ds_read_b64_tr_b16 v[58:59], v10 offset:32000
  v_rcp_f32 v15, v15
  v_mul_f32 v102, v102, v14
  v_cvt_pk_bf16_f32 v120, v100, v101
  s_waitcnt lgkmcnt(8)
  v_mfma_f32_32x32x16_bf16 v[60:75], v[36:39], v[232:235], v[60:75]
  v_mul_f32 v19, s17, v107
  v_exp_f32 v18, v18
  v_add_f32 v17, 1.0, v17
  v_mfma_f32_32x32x16_bf16 v[60:75], v[40:43], v[236:239], v[60:75]
  v_rcp_f32 v16, v16
  v_mul_f32 v103, v103, v15
  v_exp_f32 v19, v19
  s_waitcnt lgkmcnt(4)
  v_mfma_f32_32x32x16_bf16 v[60:75], v[44:47], v[240:243], v[60:75]
  v_add_f32 v18, 1.0, v18
  v_rcp_f32 v17, v17
  v_mul_f32 v104, v104, v16
  v_mfma_f32_32x32x16_bf16 v[60:75], v[48:51], v[244:247], v[60:75]
  v_cvt_pk_bf16_f32 v121, v102, v103
  v_add_f32 v19, 1.0, v19
  v_rcp_f32 v18, v18
  s_waitcnt lgkmcnt(0)
  v_mfma_f32_32x32x16_bf16 v[60:75], v[52:55], v[248:251], v[60:75]
  v_mul_f32 v105, v105, v17
  v_rcp_f32 v19, v19
  v_mul_f32 v106, v106, v18
  v_mfma_f32_32x32x16_bf16 v[60:75], v[56:59], v[252:255], v[60:75]
  s_mov_b64 exec, 1
  ds_write_b64 v22, v[124:125] offset:192
  s_mov_b64 exec, -1
  ds_read_b64 v[202:203], v23 offset:128
  v_cvt_pk_bf16_f32 v122, v104, v105
  v_mul_f32 v107, v107, v19
  v_cvt_pk_bf16_f32 v123, v106, v107
  s_and_b32 s56, s2, 7
  s_lshl_b32 s56, s56, 2
  s_lshr_b32 s15, s2, 3
  s_and_b32 s16, s15, 3
  s_add_u32 s56, s56, s16
  s_lshr_b32 s48, s15, 2
  s_lshl_b32 s57, s48, 3
  s_add_u32 s57, s57, s12
  s_lshl_b32 s58, s56, 17
  s_add_u32 s58, s58, 2097152

  s_nop 0
  s_mov_b32 s17, 0xbfb8aa3b
  v_mul_f32 v12, s17, v60
  v_mul_f32 v13, s17, v61
  v_exp_f32 v12, v12
  v_mul_f32 v14, s17, v62
  v_exp_f32 v13, v13
  v_add_f32 v12, 1.0, v12
  v_mul_f32 v15, s17, v63
  v_exp_f32 v14, v14
  v_add_f32 v13, 1.0, v13
  v_rcp_f32 v12, v12
  v_mul_f32 v16, s17, v64
  v_exp_f32 v15, v15
  v_add_f32 v14, 1.0, v14
  v_rcp_f32 v13, v13
  v_mul_f32 v60, v60, v12
  v_mul_f32 v17, s17, v65
  v_exp_f32 v16, v16
  v_add_f32 v15, 1.0, v15
  v_rcp_f32 v14, v14
  v_mul_f32 v61, v61, v13
  v_mul_f32 v18, s17, v66
  v_exp_f32 v17, v17
  v_add_f32 v16, 1.0, v16
  v_rcp_f32 v15, v15
  v_mul_f32 v62, v62, v14
  v_cvt_pk_bf16_f32 v128, v60, v61
  v_mul_f32 v19, s17, v67
  v_exp_f32 v18, v18
  v_add_f32 v17, 1.0, v17
  v_rcp_f32 v16, v16
  v_mul_f32 v63, v63, v15
  v_mul_f32 v12, s17, v68
  v_exp_f32 v19, v19
  v_add_f32 v18, 1.0, v18
  v_rcp_f32 v17, v17
  v_mul_f32 v64, v64, v16
  v_cvt_pk_bf16_f32 v129, v62, v63
  v_mul_f32 v13, s17, v69
  v_exp_f32 v12, v12
  v_add_f32 v19, 1.0, v19
  v_rcp_f32 v18, v18
  v_mul_f32 v65, v65, v17
  v_mul_f32 v14, s17, v70
  v_exp_f32 v13, v13
  v_add_f32 v12, 1.0, v12
  v_rcp_f32 v19, v19
  v_mul_f32 v66, v66, v18
  v_cvt_pk_bf16_f32 v130, v64, v65
  v_mul_f32 v15, s17, v71
  v_exp_f32 v14, v14
  v_add_f32 v13, 1.0, v13
  v_rcp_f32 v12, v12
  v_mul_f32 v67, v67, v19
  v_mul_f32 v16, s17, v72
  v_exp_f32 v15, v15
  v_add_f32 v14, 1.0, v14
  v_rcp_f32 v13, v13
  v_mul_f32 v68, v68, v12
  v_cvt_pk_bf16_f32 v131, v66, v67
  v_mul_f32 v17, s17, v73
  v_exp_f32 v16, v16
  v_add_f32 v15, 1.0, v15
  v_rcp_f32 v14, v14
  v_mul_f32 v69, v69, v13
  v_mul_f32 v18, s17, v74
  v_exp_f32 v17, v17
  v_add_f32 v16, 1.0, v16
  v_rcp_f32 v15, v15
  v_mul_f32 v70, v70, v14
  v_cvt_pk_bf16_f32 v132, v68, v69
  v_mul_f32 v19, s17, v75
  v_exp_f32 v18, v18
  v_add_f32 v17, 1.0, v17
  v_rcp_f32 v16, v16
  v_mul_f32 v71, v71, v15
  v_exp_f32 v19, v19
  v_add_f32 v18, 1.0, v18
  v_rcp_f32 v17, v17
  v_mul_f32 v72, v72, v16
  v_cvt_pk_bf16_f32 v133, v70, v71
  v_add_f32 v19, 1.0, v19
  v_rcp_f32 v18, v18
  v_mul_f32 v73, v73, v17
  v_rcp_f32 v19, v19
  v_mul_f32 v74, v74, v18
  v_cvt_pk_bf16_f32 v134, v72, v73
  v_mul_f32 v75, v75, v19
  v_cvt_pk_bf16_f32 v135, v74, v75
L_attC:
  v_lshlrev_b32 v1, 4, v2
  s_lshr_b32 s27, s12, 1
  s_mul_i32 s17, s27, 28672
  s_mul_i32 s24, s48, 294912
  s_add_u32 s24, s24, 16842752
  s_lshl_b32 s15, s27, 13
  s_add_u32 s28, s24, s15
  s_add_u32 s24, s24, s17
  s_add_u32 s24, s24, 32768
  s_add_u32 s25, s24, 147456
  s_lshl_b32 s26, s56, 1
  s_and_b32 s16, s12, 1
  s_add_u32 s18, s26, s16
  s_mul_i32 s26, s18, 114688
  s_add_u32 s26, s26, s17
  s_add_u32 s26, s26, 8388608
  v_add_u32 v4, 65536, v1
  v_and_b32 v5, 15, v2
  v_lshlrev_b32 v5, 4, v5
  v_and_b32 v6, 32, v2
  v_lshlrev_b32 v6, 3, v6
  v_add_u32 v3, v5, v6
  v_add_u32 v3, 77824, v3
  s_mov_b32 s30, 0x0000ffff
  s_mov_b32 s31, 0x0000ffff

  s_mov_b32 s15, 0x3f803f80
  v_and_b32 v5, 27, v2
  v_cmp_eq_u32 vcc, 16, v5
  v_mov_b32 v6, s15
  s_lshl_b32 s15, s12, 10
  v_cndmask_b32 v5, 0, v6, vcc
  v_add_u32 v6, s15, v4

  v_and_b32 v37, 0x330, v1
  v_and_b32 v38, 64, v1
  v_lshl_or_b32 v37, v38, 1, v37
  v_and_b32 v38, 128, v1
  v_lshrrev_b32 v38, 1, v38
  v_or_b32 v37, v37, v38
  v_add_u32 v4, 65536, v37
  v_mov_b32 v20, v5
  v_mov_b32 v21, v5
  v_mov_b32 v22, v5
  v_mov_b32 v23, v5
  v_mov_b32 v24, v5
  v_mov_b32 v25, v5
  v_mov_b32 v26, v5
  v_mov_b32 v27, v5
  v_mov_b32 v28, v5
  v_mov_b32 v29, v5
  v_mov_b32 v30, v5
  v_mov_b32 v31, v5
  v_mov_b32 v32, v5
  v_mov_b32 v33, v5
  v_mov_b32 v34, v5
  v_mov_b32 v35, v5
  v_mov_b32 v56, v5
  v_mov_b32 v57, v5
  v_mov_b32 v58, v5
  v_mov_b32 v59, v5
  v_and_b32 v0, 3, v2
  v_lshlrev_b32 v0, 3, v0
  v_add_u32 v0, 89088, v0

  v_mov_b32 v242, s72
  v_mov_b32 v243, s73
  v_mov_b32 v244, 0
  v_mov_b32 v36, 0xdddddddd
  v_mov_b32 v92, 0
  v_mov_b32 v93, 0
  v_mov_b32 v94, 0
  v_mov_b32 v95, 0
  v_mov_b32 v96, 0
  v_mov_b32 v97, 0
  v_mov_b32 v98, 0
  v_mov_b32 v99, 0
  v_mov_b32 v100, 0
  v_mov_b32 v101, 0
  v_mov_b32 v102, 0
  v_mov_b32 v103, 0
  v_mov_b32 v104, 0
  v_mov_b32 v105, 0
  v_mov_b32 v106, 0
  v_mov_b32 v107, 0

  v_add_u32 v253, 53248, v3
  v_mov_b32 v248, v5
  v_mov_b32 v249, v5
  v_mov_b32 v250, v5
  v_mov_b32 v251, v5
  s_waitcnt lgkmcnt(0)
  v_cmp_ne_u64 vcc, s[72:73], v[202:203]
  s_nop 0
  s_cbranch_vccnz L_wc21
L_wr21:
  ds_read_b128 v[8:11], v6 offset:24576
  ds_read_b128 v[12:15], v4 offset:0
  ds_read_b128 v[16:19], v4 offset:1024
  s_mov_b64 exec, s[30:31]
  ds_read_b128 v[20:23], v3 offset:0
  ds_read_b128 v[24:27], v3 offset:512
  s_mov_b64 exec, -1
  s_waitcnt lgkmcnt(3)
  v_mfma_f32_32x32x16_bf16 v[60:75], v[12:15], v[8:11], 0
  s_setprio 3
  s_nop 7
  s_nop 3
  v_exp_f32 v60, v60
  v_exp_f32 v61, v61
  s_mov_b64 exec, s[30:31]
  ds_read_b128 v[28:31], v3 offset:1024
  ds_read_b128 v[32:35], v3 offset:1536
  ds_read_b128 v[56:59], v3 offset:2048
  ds_read_b128 v[248:251], v3 offset:2560
  s_mov_b64 exec, -1
  v_exp_f32 v62, v62
  s_waitcnt lgkmcnt(4)
  v_mfma_f32_32x32x16_bf16 v[76:91], v[16:19], v[8:11], 0
  ds_read_b128 v[12:15], v4 offset:2048
  v_exp_f32 v63, v63
  v_exp_f32 v64, v64
  v_exp_f32 v65, v65
  v_exp_f32 v66, v66
  v_exp_f32 v67, v67
  v_exp_f32 v68, v68
  v_exp_f32 v69, v69
  v_exp_f32 v70, v70
  v_exp_f32 v71, v71
  v_smfmac_f32_32x32x32_bf16 v[92:107], v[20:23], v[60:67], v36
  buffer_store_dwordx4 v[108:111], v1, s[32:35], s53 offen offset:0 sc1
  buffer_store_dwordx4 v[112:115], v1, s[32:35], s53 offen offset:1024 sc1
  v_exp_f32 v72, v72
  v_exp_f32 v73, v73
  v_exp_f32 v74, v74
  v_exp_f32 v75, v75
  v_exp_f32 v76, v76
  v_exp_f32 v77, v77
  v_smfmac_f32_32x32x32_bf16 v[92:107], v[24:27], v[68:75], v36
  v_exp_f32 v78, v78
  s_waitcnt lgkmcnt(0)
  v_mfma_f32_32x32x16_bf16 v[60:75], v[12:15], v[8:11], 0
  ds_read_b128 v[16:19], v4 offset:3072
  v_exp_f32 v79, v79
  v_exp_f32 v80, v80
  v_exp_f32 v81, v81
  v_exp_f32 v82, v82
  v_exp_f32 v83, v83
  v_exp_f32 v84, v84
  v_exp_f32 v85, v85
  v_exp_f32 v86, v86
  v_exp_f32 v87, v87
  v_smfmac_f32_32x32x32_bf16 v[92:107], v[28:31], v[76:83], v36
  buffer_store_dwordx4 v[116:119], v1, s[32:35], s53 offen offset:2048 sc1
  buffer_store_dwordx4 v[120:123], v1, s[32:35], s53 offen offset:3072 sc1
  v_exp_f32 v88, v88
  v_exp_f32 v89, v89
  v_exp_f32 v90, v90
  v_exp_f32 v91, v91
  v_exp_f32 v60, v60
  v_exp_f32 v61, v61
  v_smfmac_f32_32x32x32_bf16 v[92:107], v[32:35], v[84:91], v36
  s_mov_b64 exec, s[30:31]
  ds_read_b128 v[20:23], v3 offset:3072
  ds_read_b128 v[24:27], v3 offset:3584
  ds_read_b128 v[28:31], v3 offset:4096
  ds_read_b128 v[32:35], v3 offset:4608
  s_mov_b64 exec, -1
  v_exp_f32 v62, v62
  s_waitcnt lgkmcnt(4)
  v_mfma_f32_32x32x16_bf16 v[76:91], v[16:19], v[8:11], 0
  ds_read_b128 v[12:15], v4 offset:4096
  v_exp_f32 v63, v63
  v_exp_f32 v64, v64
  v_exp_f32 v65, v65
  v_exp_f32 v66, v66
  v_exp_f32 v67, v67
  v_exp_f32 v68, v68
  v_exp_f32 v69, v69
  v_exp_f32 v70, v70
  v_exp_f32 v71, v71
  v_smfmac_f32_32x32x32_bf16 v[92:107], v[56:59], v[60:67], v36
  buffer_store_dwordx4 v[128:131], v1, s[32:35], s54 offen offset:0 sc1
  buffer_store_dwordx4 v[132:135], v1, s[32:35], s54 offen offset:1024 sc1
  v_exp_f32 v72, v72
  v_exp_f32 v73, v73
  v_exp_f32 v74, v74
  v_exp_f32 v75, v75
  v_exp_f32 v76, v76
  v_exp_f32 v77, v77
  v_smfmac_f32_32x32x32_bf16 v[92:107], v[248:251], v[68:75], v36
  v_exp_f32 v78, v78
  s_waitcnt lgkmcnt(0)
  v_mfma_f32_32x32x16_bf16 v[60:75], v[12:15], v[8:11], 0
  ds_read_b128 v[16:19], v4 offset:5120
  v_exp_f32 v79, v79
  v_exp_f32 v80, v80
  v_exp_f32 v81, v81
  v_exp_f32 v82, v82
  v_exp_f32 v83, v83
  v_exp_f32 v84, v84
  v_exp_f32 v85, v85
  v_exp_f32 v86, v86
  v_exp_f32 v87, v87
  v_smfmac_f32_32x32x32_bf16 v[92:107], v[20:23], v[76:83], v36
  s_cmp_lg_u32 s3, 0
  s_cbranch_scc1 L_noh4
  buffer_store_dwordx4 v[136:139], v1, s[32:35], s54 offen offset:2048 sc1
  buffer_store_dwordx4 v[140:143], v1, s[32:35], s54 offen offset:3072 sc1
L_noh4:
  v_exp_f32 v88, v88
  v_exp_f32 v89, v89
  v_exp_f32 v90, v90
  v_exp_f32 v91, v91
  s_setprio 2
  v_exp_f32 v60, v60
  v_exp_f32 v61, v61
  v_smfmac_f32_32x32x32_bf16 v[92:107], v[24:27], v[84:91], v36
  s_mov_b64 exec, s[30:31]
  ds_read_b128 v[56:59], v3 offset:5120
  ds_read_b128 v[248:251], v3 offset:5632
  ds_read_b128 v[20:23], v3 offset:6144
  ds_read_b128 v[24:27], v3 offset:6656
  s_mov_b64 exec, -1
  v_exp_f32 v62, v62
  s_waitcnt lgkmcnt(4)
  v_mfma_f32_32x32x16_bf16 v[76:91], v[16:19], v[8:11], 0
  ds_read_b128 v[12:15], v4 offset:6144
  v_exp_f32 v63, v63
  v_exp_f32 v64, v64
  v_exp_f32 v65, v65
  v_exp_f32 v66, v66
  v_exp_f32 v67, v67
  v_exp_f32 v68, v68
  v_exp_f32 v69, v69
  v_exp_f32 v70, v70
  v_exp_f32 v71, v71
  v_smfmac_f32_32x32x32_bf16 v[92:107], v[28:31], v[60:67], v36
  v_mov_b32 v204, -1
  v_mov_b32 v205, -1
  v_mov_b32 v206, -1
  v_mov_b32 v207, -1
  buffer_store_dwordx4 v[204:207], v1, s[32:35], s99 offen offset:0 sc1
  buffer_store_dwordx4 v[204:207], v1, s[32:35], s99 offen offset:1024 sc1
  v_exp_f32 v72, v72
  v_exp_f32 v73, v73
  v_exp_f32 v74, v74
  v_exp_f32 v75, v75
  v_exp_f32 v76, v76
  v_exp_f32 v77, v77
  v_smfmac_f32_32x32x32_bf16 v[92:107], v[32:35], v[68:75], v36
  v_exp_f32 v78, v78
  s_waitcnt lgkmcnt(0)
  v_mfma_f32_32x32x16_bf16 v[60:75], v[12:15], v[8:11], 0
  ds_read_b128 v[16:19], v4 offset:7168
  v_exp_f32 v79, v79
  v_exp_f32 v80, v80
  v_exp_f32 v81, v81
  v_exp_f32 v82, v82
  v_exp_f32 v83, v83
  v_exp_f32 v84, v84
  v_exp_f32 v85, v85
  v_exp_f32 v86, v86
  v_exp_f32 v87, v87
  v_smfmac_f32_32x32x32_bf16 v[92:107], v[56:59], v[76:83], v36
  v_exp_f32 v88, v88
  v_exp_f32 v89, v89
  v_exp_f32 v90, v90
  v_exp_f32 v91, v91
  v_exp_f32 v60, v60
  v_exp_f32 v61, v61
  v_smfmac_f32_32x32x32_bf16 v[92:107], v[248:251], v[84:91], v36
  s_mov_b64 exec, s[30:31]
  ds_read_b128 v[28:31], v3 offset:7168
  ds_read_b128 v[32:35], v3 offset:7680
  ds_read_b128 v[56:59], v3 offset:8192
  ds_read_b128 v[248:251], v3 offset:8704
  s_mov_b64 exec, -1
  v_exp_f32 v62, v62
  s_waitcnt lgkmcnt(4)
  v_mfma_f32_32x32x16_bf16 v[76:91], v[16:19], v[8:11], 0
  ds_read_b128 v[12:15], v4 offset:8192
  v_exp_f32 v63, v63
  v_exp_f32 v64, v64
  v_exp_f32 v65, v65
  v_exp_f32 v66, v66
  v_exp_f32 v67, v67
  v_exp_f32 v68, v68
  v_exp_f32 v69, v69
  v_exp_f32 v70, v70
  v_exp_f32 v71, v71
  v_smfmac_f32_32x32x32_bf16 v[92:107], v[20:23], v[60:67], v36
  v_exp_f32 v72, v72
  v_exp_f32 v73, v73
  v_exp_f32 v74, v74
  v_exp_f32 v75, v75
  s_setprio 1
  v_exp_f32 v76, v76
  v_exp_f32 v77, v77
  v_smfmac_f32_32x32x32_bf16 v[92:107], v[24:27], v[68:75], v36
  v_exp_f32 v78, v78
  s_waitcnt lgkmcnt(0)
  v_mfma_f32_32x32x16_bf16 v[60:75], v[12:15], v[8:11], 0
  ds_read_b128 v[16:19], v4 offset:9216
  v_exp_f32 v79, v79
  v_exp_f32 v80, v80
  v_exp_f32 v81, v81
  v_exp_f32 v82, v82
  v_exp_f32 v83, v83
  v_exp_f32 v84, v84
  v_exp_f32 v85, v85
  v_exp_f32 v86, v86
  v_exp_f32 v87, v87
  v_smfmac_f32_32x32x32_bf16 v[92:107], v[28:31], v[76:83], v36
  v_exp_f32 v88, v88
  v_exp_f32 v89, v89
  v_exp_f32 v90, v90
  v_exp_f32 v91, v91
  v_exp_f32 v60, v60
  v_exp_f32 v61, v61
  v_smfmac_f32_32x32x32_bf16 v[92:107], v[32:35], v[84:91], v36
  s_mov_b64 exec, s[30:31]
  ds_read_b128 v[20:23], v3 offset:9216
  ds_read_b128 v[24:27], v3 offset:9728
  ds_read_b128 v[28:31], v3 offset:10240
  ds_read_b128 v[32:35], v3 offset:10752
  s_mov_b64 exec, -1
  v_exp_f32 v62, v62
  s_waitcnt lgkmcnt(4)
  v_mfma_f32_32x32x16_bf16 v[76:91], v[16:19], v[8:11], 0
  ds_read_b128 v[12:15], v4 offset:10240
  v_exp_f32 v63, v63
  v_exp_f32 v64, v64
  v_exp_f32 v65, v65
  v_exp_f32 v66, v66
  v_exp_f32 v67, v67
  v_exp_f32 v68, v68
  v_exp_f32 v69, v69
  v_exp_f32 v70, v70
  v_exp_f32 v71, v71
  v_smfmac_f32_32x32x32_bf16 v[92:107], v[56:59], v[60:67], v36
  v_exp_f32 v72, v72
  v_exp_f32 v73, v73
  v_exp_f32 v74, v74
  v_exp_f32 v75, v75
  v_exp_f32 v76, v76
  v_exp_f32 v77, v77
  v_smfmac_f32_32x32x32_bf16 v[92:107], v[248:251], v[68:75], v36
  v_exp_f32 v78, v78
  s_waitcnt lgkmcnt(0)
  v_mfma_f32_32x32x16_bf16 v[60:75], v[12:15], v[8:11], 0
  ds_read_b128 v[16:19], v4 offset:11264
  v_exp_f32 v79, v79
  v_exp_f32 v80, v80
  v_exp_f32 v81, v81
  v_exp_f32 v82, v82
  v_exp_f32 v83, v83
  v_exp_f32 v84, v84
  v_exp_f32 v85, v85
  v_exp_f32 v86, v86
  v_exp_f32 v87, v87
  v_smfmac_f32_32x32x32_bf16 v[92:107], v[20:23], v[76:83], v36
  ds_read_b64 v[202:203], v0 offset:160
  s_waitcnt vmcnt(0)
  s_mov_b64 exec, 1
  buffer_store_dwordx2 v[242:243], v244, s[32:35], s49 offen sc1
  s_mov_b64 exec, -1
  v_exp_f32 v88, v88
  v_exp_f32 v89, v89
  v_exp_f32 v90, v90
  v_exp_f32 v91, v91
  s_waitcnt lgkmcnt(0)
  v_cmp_ne_u64 vcc, s[72:73], v[202:203]
  s_nop 0
  s_cbranch_vccnz L_wc23
L_wr23:
  s_setprio 0
  v_exp_f32 v60, v60
  v_exp_f32 v61, v61
  v_smfmac_f32_32x32x32_bf16 v[92:107], v[24:27], v[84:91], v36
  s_mov_b64 exec, s[30:31]
  ds_read_b128 v[56:59], v253 offset:0
  ds_read_b128 v[248:251], v253 offset:512
  ds_read_b128 v[20:23], v253 offset:1024
  ds_read_b128 v[24:27], v253 offset:1536
  s_mov_b64 exec, -1
  v_exp_f32 v62, v62
  v_mfma_f32_32x32x16_bf16 v[76:91], v[16:19], v[8:11], 0
  ds_read_b128 v[12:15], v4 offset:32768
  v_exp_f32 v63, v63
  v_exp_f32 v64, v64
  v_exp_f32 v65, v65
  v_exp_f32 v66, v66
  v_exp_f32 v67, v67
  v_exp_f32 v68, v68
  v_exp_f32 v69, v69
  v_exp_f32 v70, v70
  v_exp_f32 v71, v71
  v_smfmac_f32_32x32x32_bf16 v[92:107], v[28:31], v[60:67], v36
  v_exp_f32 v72, v72
  v_exp_f32 v73, v73
  v_exp_f32 v74, v74
  v_exp_f32 v75, v75
  v_exp_f32 v76, v76
  v_exp_f32 v77, v77
  v_smfmac_f32_32x32x32_bf16 v[92:107], v[32:35], v[68:75], v36
  v_exp_f32 v78, v78
  s_waitcnt lgkmcnt(0)
  v_mfma_f32_32x32x16_bf16 v[60:75], v[12:15], v[8:11], 0
  ds_read_b128 v[16:19], v4 offset:33792
  v_exp_f32 v79, v79
  v_exp_f32 v80, v80
  v_exp_f32 v81, v81
  v_exp_f32 v82, v82
  v_exp_f32 v83, v83
  v_exp_f32 v84, v84
  v_exp_f32 v85, v85
  v_exp_f32 v86, v86
  v_exp_f32 v87, v87
  v_smfmac_f32_32x32x32_bf16 v[92:107], v[56:59], v[76:83], v36
  v_exp_f32 v88, v88
  v_exp_f32 v89, v89
  v_exp_f32 v90, v90
  v_exp_f32 v91, v91
  s_branch L_join
L_attL:
  v_lshlrev_b32 v1, 4, v2
  s_lshr_b32 s27, s12, 1
  s_mul_i32 s17, s27, 28672
  s_mul_i32 s24, s48, 294912
  s_add_u32 s24, s24, 16842752
  s_lshl_b32 s15, s27, 13
  s_add_u32 s28, s24, s15
  s_add_u32 s24, s24, s17
  s_add_u32 s24, s24, 32768
  s_add_u32 s25, s24, 147456
  s_lshl_b32 s26, s56, 1
  s_and_b32 s16, s12, 1
  s_add_u32 s18, s26, s16
  s_mul_i32 s26, s18, 114688
  s_add_u32 s26, s26, s17
  s_add_u32 s26, s26, 8388608
  v_add_u32 v4, 65536, v1
  v_and_b32 v5, 15, v2
  v_lshlrev_b32 v5, 4, v5
  v_and_b32 v6, 32, v2
  v_lshlrev_b32 v6, 3, v6
  v_add_u32 v3, v5, v6
  v_add_u32 v3, 77824, v3
  s_mov_b32 s30, 0x0000ffff
  s_mov_b32 s31, 0x0000ffff

  s_mov_b32 s15, 0x3f803f80
  v_and_b32 v5, 27, v2
  v_cmp_eq_u32 vcc, 16, v5
  v_mov_b32 v6, s15
  s_lshl_b32 s15, s12, 10
  v_cndmask_b32 v5, 0, v6, vcc
  v_add_u32 v6, s15, v4

  v_and_b32 v37, 0x330, v1
  v_and_b32 v38, 64, v1
  v_lshl_or_b32 v37, v38, 1, v37
  v_and_b32 v38, 128, v1
  v_lshrrev_b32 v38, 1, v38
  v_or_b32 v37, v37, v38
  v_add_u32 v4, 65536, v37
  v_mov_b32 v20, v5
  v_mov_b32 v21, v5
  v_mov_b32 v22, v5
  v_mov_b32 v23, v5
  v_mov_b32 v24, v5
  v_mov_b32 v25, v5
  v_mov_b32 v26, v5
  v_mov_b32 v27, v5
  v_mov_b32 v28, v5
  v_mov_b32 v29, v5
  v_mov_b32 v30, v5
  v_mov_b32 v31, v5
  v_mov_b32 v32, v5
  v_mov_b32 v33, v5
  v_mov_b32 v34, v5
  v_mov_b32 v35, v5
  v_mov_b32 v56, v5
  v_mov_b32 v57, v5
  v_mov_b32 v58, v5
  v_mov_b32 v59, v5
  v_and_b32 v0, 3, v2
  v_lshlrev_b32 v0, 3, v0
  v_add_u32 v0, 89088, v0

  s_sub_u32 s22, s12, 4
  s_mul_i32 s20, s22, 5120
  s_add_u32 s21, s58, s20
  s_lshl_b32 s42, 1, s22
  s_mov_b32 s43, 0
  s_lshl_b32 s15, s22, 3
  s_lshl_b32 s16, s56, 16
  s_lshl_b32 s17, s48, 13
  s_add_u32 s16, s16, s17
  s_add_u32 s16, s16, 4294942720
  s_add_u32 s17, s58, 53248
  s_lshr_b32 s4, 0x06070300, s15
  s_and_b32 s4, s4, 0xff
  s_lshr_b32 s6, 0x05020401, s15
  s_and_b32 s6, s6, 0xff
  s_cmp_ge_u32 s4, 3
  s_cselect_b32 s5, s17, s58
  s_cmp_ge_u32 s4, 6
  s_cselect_b32 s5, s16, s5
  s_cmp_ge_u32 s6, 3
  s_cselect_b32 s7, s17, s58
  s_lshl_b32 s4, s4, 12
  s_lshl_b32 s6, s6, 12
  s_add_u32 s5, s5, s4
  s_add_u32 s7, s7, s6
  s_add_u32 s4, s4, 65536
  s_add_u32 s6, s6, 65536
  s_cmp_eq_u32 s22, 3
  s_cselect_b32 s8, s4, s6
  s_cselect_b32 s9, s5, s7
  s_and_b32 s15, s22, 1
  s_lshr_b32 s16, s22, 1
  s_lshl_b32 s16, s16, 12
  s_lshl_b32 s36, s15, 15
  s_add_u32 s36, s36, s16
  s_add_u32 s36, s36, 98304
  s_mul_i32 s37, s15, 64512
  s_add_u32 s37, s37, s16
  s_add_u32 s37, s37, s58
  s_add_u32 s37, s37, 12288

  v_lshlrev_b32 v64, 7, v2
  s_lshl_b32 s38, s13, 9
  s_lshl_b32 s15, s22, 7
  s_add_u32 s38, s38, s15
  s_add_u32 s38, s38, 25821184
  s_cmp_eq_u32 s14, 1
  s_cselect_b32 s38, s38, 0
  s_cmp_lg_u32 s22, 0
  s_cbranch_scc1 L_un

  s_lshr_b32 s39, s56, 2
  s_lshl_b32 s39, s39, 14
  s_add_u32 s39, s39, 25165824
  v_add_u32 v65, 8192, v64

  buffer_load_dwordx2 v[66:67], v64, s[32:35], s39 offen sc1
  buffer_load_dwordx2 v[68:69], v65, s[32:35], s39 offen sc1

  s_cmp_lg_u32 s3, 0
  s_cbranch_scc1 L_u0o
  s_waitcnt vmcnt(2)

L_u0o:
  s_waitcnt vmcnt(10)
  s_mov_b64 exec, 1
  ds_write_b64 v0, v[52:53] offset:0
  s_mov_b64 exec, -1
  s_mov_b32 s95, 0
L_fpoll:
  s_add_u32 s95, s95, 1
  s_waitcnt vmcnt(0)
  v_cmp_ne_u64 s[40:41], s[72:73], v[66:67]
  v_cmp_ne_u64 s[90:91], s[72:73], v[68:69]
  s_cmp_gt_u32 s95, 20000
  s_cbranch_scc1 L_fpd
  s_or_b64 s[40:41], s[40:41], s[90:91]
  s_cbranch_scc0 L_fpd
  s_mov_b64 exec, s[40:41]
  s_sleep 1

L_fpl:
  buffer_load_dwordx2 v[66:67], v64, s[32:35], s39 offen sc1
  buffer_load_dwordx2 v[68:69], v65, s[32:35], s39 offen sc1
  s_branch L_fpoll

L_fpd:
  s_mov_b64 exec, 15
  ds_write_b64 v0, v[52:53] offset:96
  s_mov_b64 exec, -1
  s_branch L_dgo
L_un:
  s_cmp_lg_u32 s3, 0
  s_cbranch_scc1 L_uno
  s_waitcnt vmcnt(0)

L_uno:
  s_waitcnt vmcnt(8)
  s_mov_b64 exec, s[42:43]
  ds_write_b64 v0, v[52:53] offset:0
  s_mov_b64 exec, -1
  s_cmp_eq_u32 s3, 0
  s_cbranch_scc1 L_dnp
  s_waitcnt vmcnt(0)
  ds_read_b64_tr_b16 v[108:109], v17 offset:0
  ds_read_b64_tr_b16 v[110:111], v17 offset:2048
  ds_read_b64_tr_b16 v[112:113], v17 offset:64
  ds_read_b64_tr_b16 v[114:115], v17 offset:2112
  ds_read_b64_tr_b16 v[116:117], v17 offset:128
  ds_read_b64_tr_b16 v[118:119], v17 offset:2176
  ds_read_b64_tr_b16 v[120:121], v17 offset:192
  ds_read_b64_tr_b16 v[122:123], v17 offset:2240
  s_waitcnt lgkmcnt(0)
  ds_read_b64_tr_b16 v[128:129], v17 offset:16384
  ds_read_b64_tr_b16 v[130:131], v17 offset:18432
  ds_read_b64_tr_b16 v[132:133], v17 offset:16448
  ds_read_b64_tr_b16 v[134:135], v17 offset:18496
  ds_read_b64_tr_b16 v[136:137], v17 offset:16512
  ds_read_b64_tr_b16 v[138:139], v17 offset:18560
  ds_read_b64_tr_b16 v[140:141], v17 offset:16576
  ds_read_b64_tr_b16 v[142:143], v17 offset:18624
  s_waitcnt lgkmcnt(0)
  buffer_store_dwordx4 v[108:111], v1, s[32:35], s60 offen sc1
  s_add_u32 s60, s60, 147456
  buffer_store_dwordx4 v[112:115], v1, s[32:35], s60 offen sc1
  s_add_u32 s60, s60, 147456
  buffer_store_dwordx4 v[116:119], v1, s[32:35], s60 offen sc1
  s_add_u32 s60, s60, 147456
  buffer_store_dwordx4 v[120:123], v1, s[32:35], s60 offen sc1
  s_cmp_ge_u32 s100, 16
  s_cbranch_scc1 L_dnp
  buffer_store_dwordx4 v[128:131], v1, s[32:35], s61 offen sc1
  s_add_u32 s61, s61, 147456
  buffer_store_dwordx4 v[132:135], v1, s[32:35], s61 offen sc1
  s_add_u32 s61, s61, 147456
  buffer_store_dwordx4 v[136:139], v1, s[32:35], s61 offen sc1
  s_add_u32 s61, s61, 147456
  buffer_store_dwordx4 v[140:143], v1, s[32:35], s61 offen sc1
L_dnp:
  s_mov_b32 s95, 0
L_ws26:
  ds_read_b64 v[62:63], v0 offset:96
  s_add_u32 s95, s95, 1
  s_waitcnt lgkmcnt(0)
  v_cmp_ne_u64 vcc, s[72:73], v[62:63]
  s_cmp_gt_u32 s95, 320000
  s_cbranch_scc1 L_wd26

  s_cbranch_vccz L_wd26
  s_sleep 1
  s_branch L_ws26
L_wd26:
L_dgo:
  ds_read_b64 v[62:63], v0 offset:64
  s_mov_b32 m0, s4
  s_nop 0
  buffer_load_dwordx4 v1, s[32:35], s5 offen offset:0 sc1 lds
  buffer_load_dwordx4 v1, s[32:35], s5 offen offset:1024 sc1 lds
  buffer_load_dwordx4 v1, s[32:35], s5 offen offset:2048 sc1 lds
  buffer_load_dwordx4 v1, s[32:35], s5 offen offset:3072 sc1 lds
  s_mov_b32 m0, s6
  s_nop 0
  buffer_load_dwordx4 v1, s[32:35], s7 offen offset:0 sc1 lds
  buffer_load_dwordx4 v1, s[32:35], s7 offen offset:1024 sc1 lds
  buffer_load_dwordx4 v1, s[32:35], s7 offen offset:2048 sc1 lds
  s_mov_b32 m0, s8
  s_waitcnt lgkmcnt(0)
  buffer_load_dwordx4 v1, s[32:35], s9 offen offset:3072 sc1 lds
  v_cmp_ne_u64 vcc, s[72:73], v[62:63]
  s_nop 0
  s_cbranch_vccnz L_wc27
L_wr27:
  v_mov_b32 v242, s72
  v_mov_b32 v243, s73
  v_mov_b32 v244, 0
  v_mov_b32 v36, 0xdddddddd
  v_mov_b32 v92, 0
  v_mov_b32 v93, 0
  v_mov_b32 v94, 0
  v_mov_b32 v95, 0
  v_mov_b32 v96, 0
  v_mov_b32 v97, 0
  v_mov_b32 v98, 0
  v_mov_b32 v99, 0
  v_mov_b32 v100, 0
  v_mov_b32 v101, 0
  v_mov_b32 v102, 0
  v_mov_b32 v103, 0
  v_mov_b32 v104, 0
  v_mov_b32 v105, 0
  v_mov_b32 v106, 0
  v_mov_b32 v107, 0

  v_add_u32 v253, 53248, v3
  v_mov_b32 v248, v5
  v_mov_b32 v249, v5
  v_mov_b32 v250, v5
  v_mov_b32 v251, v5
  s_waitcnt vmcnt(0)
  s_mov_b64 exec, s[42:43]
  ds_write_b64 v0, v[52:53] offset:128
  s_mov_b64 exec, -1
  s_cmp_eq_u32 s38, 0
  s_cbranch_scc1 L_ngf
  s_mov_b64 exec, 1
  buffer_store_dwordx2 v[52:53], v54, s[32:35], s38 offen sc1
  s_mov_b64 exec, -1
L_ngf:
  s_mov_b32 m0, s36
  s_add_u32 s36, s36, 8192
  buffer_load_dwordx4 v1, s[32:35], s37 offen offset:0 sc1 lds
  buffer_load_dwordx4 v1, s[32:35], s37 offen offset:1024 sc1 lds
  buffer_load_dwordx4 v1, s[32:35], s37 offen offset:2048 sc1 lds
  buffer_load_dwordx4 v1, s[32:35], s37 offen offset:3072 sc1 lds
  s_add_u32 s37, s37, 8192
  s_mov_b32 m0, s36
  s_add_u32 s36, s36, 8192
  buffer_load_dwordx4 v1, s[32:35], s37 offen offset:0 sc1 lds
  buffer_load_dwordx4 v1, s[32:35], s37 offen offset:1024 sc1 lds
  buffer_load_dwordx4 v1, s[32:35], s37 offen offset:2048 sc1 lds
  buffer_load_dwordx4 v1, s[32:35], s37 offen offset:3072 sc1 lds
  s_add_u32 s37, s37, 8192
  s_mov_b32 m0, s36
  s_add_u32 s36, s36, 8192
  buffer_load_dwordx4 v1, s[32:35], s37 offen offset:0 sc1 lds
  buffer_load_dwordx4 v1, s[32:35], s37 offen offset:1024 sc1 lds
  buffer_load_dwordx4 v1, s[32:35], s37 offen offset:2048 sc1 lds
  buffer_load_dwordx4 v1, s[32:35], s37 offen offset:3072 sc1 lds
  s_add_u32 s37, s37, 8192
  s_mov_b32 m0, s36
  s_nop 0
  buffer_load_dwordx4 v1, s[32:35], s37 offen offset:0 sc1 lds
  buffer_load_dwordx4 v1, s[32:35], s37 offen offset:1024 sc1 lds
  buffer_load_dwordx4 v1, s[32:35], s37 offen offset:2048 sc1 lds
  buffer_load_dwordx4 v1, s[32:35], s37 offen offset:3072 sc1 lds
  s_or_b32 s15, s22, s11
  s_cmp_eq_u32 s15, 0
  s_cbranch_scc1 L_jl
L_jlr:
  s_mov_b32 s95, 0
L_ws29:
  ds_read_b64 v[62:63], v0 offset:128
  s_add_u32 s95, s95, 1
  s_waitcnt lgkmcnt(0)
  v_cmp_ne_u64 vcc, s[72:73], v[62:63]
  s_cmp_gt_u32 s95, 320000
  s_cbranch_scc1 L_wd29

  s_cbranch_vccnz L_ws29
L_wd29:
  ds_read_b128 v[8:11], v6 offset:24576
  ds_read_b128 v[12:15], v4 offset:0
  ds_read_b128 v[16:19], v4 offset:1024
  s_mov_b64 exec, s[30:31]
  ds_read_b128 v[20:23], v3 offset:0
  ds_read_b128 v[24:27], v3 offset:512
  s_mov_b64 exec, -1
  s_waitcnt lgkmcnt(3)
  v_mfma_f32_32x32x16_bf16 v[60:75], v[12:15], v[8:11], 0
  s_setprio 3
  s_nop 7
  s_nop 3
  v_exp_f32 v60, v60
  v_exp_f32 v61, v61
  s_mov_b64 exec, s[30:31]
  ds_read_b128 v[28:31], v3 offset:1024
  ds_read_b128 v[32:35], v3 offset:1536
  ds_read_b128 v[56:59], v3 offset:2048
  ds_read_b128 v[248:251], v3 offset:2560
  s_mov_b64 exec, -1
  v_exp_f32 v62, v62
  s_waitcnt lgkmcnt(4)
  v_mfma_f32_32x32x16_bf16 v[76:91], v[16:19], v[8:11], 0
  ds_read_b128 v[12:15], v4 offset:2048
  v_exp_f32 v63, v63
  v_exp_f32 v64, v64
  v_exp_f32 v65, v65
  v_exp_f32 v66, v66
  v_exp_f32 v67, v67
  v_exp_f32 v68, v68
  v_exp_f32 v69, v69
  v_exp_f32 v70, v70
  v_exp_f32 v71, v71
  v_smfmac_f32_32x32x32_bf16 v[92:107], v[20:23], v[60:67], v36
  s_cmp_lg_u32 s11, 0
  s_cbranch_scc1 L_now2
  buffer_store_dwordx4 v[108:111], v1, s[32:35], s60 offen sc1
  s_add_u32 s60, s60, 147456
  buffer_store_dwordx4 v[112:115], v1, s[32:35], s60 offen sc1
  s_add_u32 s60, s60, 147456
  buffer_store_dwordx4 v[116:119], v1, s[32:35], s60 offen sc1
  s_add_u32 s60, s60, 147456
  buffer_store_dwordx4 v[120:123], v1, s[32:35], s60 offen sc1
  s_cmp_ge_u32 s100, 16
  s_cbranch_scc1 L_now2
  buffer_store_dwordx4 v[128:131], v1, s[32:35], s61 offen sc1
  s_add_u32 s61, s61, 147456
  buffer_store_dwordx4 v[132:135], v1, s[32:35], s61 offen sc1
  s_add_u32 s61, s61, 147456
  buffer_store_dwordx4 v[136:139], v1, s[32:35], s61 offen sc1
  s_add_u32 s61, s61, 147456
  buffer_store_dwordx4 v[140:143], v1, s[32:35], s61 offen sc1
L_now2:
  v_exp_f32 v72, v72
  v_exp_f32 v73, v73
  v_exp_f32 v74, v74
  v_exp_f32 v75, v75
  v_exp_f32 v76, v76
  v_exp_f32 v77, v77
  v_smfmac_f32_32x32x32_bf16 v[92:107], v[24:27], v[68:75], v36
  v_exp_f32 v78, v78
  s_waitcnt lgkmcnt(0)
  v_mfma_f32_32x32x16_bf16 v[60:75], v[12:15], v[8:11], 0
  ds_read_b128 v[16:19], v4 offset:3072
  v_exp_f32 v79, v79
  v_exp_f32 v80, v80
  v_exp_f32 v81, v81
  v_exp_f32 v82, v82
  v_exp_f32 v83, v83
  v_exp_f32 v84, v84
  v_exp_f32 v85, v85
  v_exp_f32 v86, v86
  v_exp_f32 v87, v87
  v_smfmac_f32_32x32x32_bf16 v[92:107], v[28:31], v[76:83], v36
  v_exp_f32 v88, v88
  v_exp_f32 v89, v89
  v_exp_f32 v90, v90
  v_exp_f32 v91, v91
  v_exp_f32 v60, v60
  v_exp_f32 v61, v61
  v_smfmac_f32_32x32x32_bf16 v[92:107], v[32:35], v[84:91], v36
  s_mov_b64 exec, s[30:31]
  ds_read_b128 v[20:23], v3 offset:3072
  ds_read_b128 v[24:27], v3 offset:3584
  ds_read_b128 v[28:31], v3 offset:4096
  ds_read_b128 v[32:35], v3 offset:4608
  s_mov_b64 exec, -1
  v_exp_f32 v62, v62
  s_waitcnt lgkmcnt(4)
  v_mfma_f32_32x32x16_bf16 v[76:91], v[16:19], v[8:11], 0
  ds_read_b128 v[12:15], v4 offset:4096
  v_exp_f32 v63, v63
  v_exp_f32 v64, v64
  v_exp_f32 v65, v65
  v_exp_f32 v66, v66
  v_exp_f32 v67, v67
  v_exp_f32 v68, v68
  v_exp_f32 v69, v69
  v_exp_f32 v70, v70
  v_exp_f32 v71, v71
  v_smfmac_f32_32x32x32_bf16 v[92:107], v[56:59], v[60:67], v36
  v_exp_f32 v72, v72
  v_exp_f32 v73, v73
  v_exp_f32 v74, v74
  v_exp_f32 v75, v75
  v_exp_f32 v76, v76
  v_exp_f32 v77, v77
  v_smfmac_f32_32x32x32_bf16 v[92:107], v[248:251], v[68:75], v36
  v_exp_f32 v78, v78
  s_waitcnt lgkmcnt(0)
  v_mfma_f32_32x32x16_bf16 v[60:75], v[12:15], v[8:11], 0
  ds_read_b128 v[16:19], v4 offset:5120
  v_exp_f32 v79, v79
  v_exp_f32 v80, v80
  v_exp_f32 v81, v81
  v_exp_f32 v82, v82
  v_exp_f32 v83, v83
  v_exp_f32 v84, v84
  v_exp_f32 v85, v85
  v_exp_f32 v86, v86
  v_exp_f32 v87, v87
  v_smfmac_f32_32x32x32_bf16 v[92:107], v[20:23], v[76:83], v36
  v_exp_f32 v88, v88
  v_exp_f32 v89, v89
  v_exp_f32 v90, v90
  v_exp_f32 v91, v91
  s_setprio 2
  v_exp_f32 v60, v60
  v_exp_f32 v61, v61
  v_smfmac_f32_32x32x32_bf16 v[92:107], v[24:27], v[84:91], v36
  s_mov_b64 exec, s[30:31]
  ds_read_b128 v[56:59], v3 offset:5120
  ds_read_b128 v[248:251], v3 offset:5632
  ds_read_b128 v[20:23], v3 offset:6144
  ds_read_b128 v[24:27], v3 offset:6656
  s_mov_b64 exec, -1
  v_exp_f32 v62, v62
  s_waitcnt lgkmcnt(4)
  v_mfma_f32_32x32x16_bf16 v[76:91], v[16:19], v[8:11], 0
  ds_read_b128 v[12:15], v4 offset:6144
  v_exp_f32 v63, v63
  v_exp_f32 v64, v64
  v_exp_f32 v65, v65
  v_exp_f32 v66, v66
  v_exp_f32 v67, v67
  v_exp_f32 v68, v68
  v_exp_f32 v69, v69
  v_exp_f32 v70, v70
  v_exp_f32 v71, v71
  v_smfmac_f32_32x32x32_bf16 v[92:107], v[28:31], v[60:67], v36
  s_waitcnt vmcnt(0)
  s_mov_b64 exec, s[42:43]
  ds_write_b64 v0, v[242:243] offset:160
  s_mov_b64 exec, -1
  s_cmp_lg_u32 s11, 1
  s_cbranch_scc1 L_fc30
L_fcr30:
  v_exp_f32 v72, v72
  v_exp_f32 v73, v73
  v_exp_f32 v74, v74
  v_exp_f32 v75, v75
  v_exp_f32 v76, v76
  v_exp_f32 v77, v77
  v_smfmac_f32_32x32x32_bf16 v[92:107], v[32:35], v[68:75], v36
  v_exp_f32 v78, v78
  s_waitcnt lgkmcnt(1)
  v_mfma_f32_32x32x16_bf16 v[60:75], v[12:15], v[8:11], 0
  ds_read_b128 v[16:19], v4 offset:7168
  v_exp_f32 v79, v79
  v_exp_f32 v80, v80
  v_exp_f32 v81, v81
  v_exp_f32 v82, v82
  v_exp_f32 v83, v83
  v_exp_f32 v84, v84
  v_exp_f32 v85, v85
  v_exp_f32 v86, v86
  v_exp_f32 v87, v87
  v_smfmac_f32_32x32x32_bf16 v[92:107], v[56:59], v[76:83], v36
  ds_read_b64 v[204:205], v0 offset:192
  ds_read_b64 v[202:203], v0 offset:160
  v_exp_f32 v88, v88
  v_exp_f32 v89, v89
  v_exp_f32 v90, v90
  v_exp_f32 v91, v91
  v_exp_f32 v60, v60
  v_exp_f32 v61, v61
  v_smfmac_f32_32x32x32_bf16 v[92:107], v[248:251], v[84:91], v36
  s_mov_b64 exec, s[30:31]
  ds_read_b128 v[28:31], v3 offset:7168
  ds_read_b128 v[32:35], v3 offset:7680
  ds_read_b128 v[56:59], v3 offset:8192
  ds_read_b128 v[248:251], v3 offset:8704
  s_mov_b64 exec, -1
  v_exp_f32 v62, v62
  s_waitcnt lgkmcnt(6)
  v_mfma_f32_32x32x16_bf16 v[76:91], v[16:19], v[8:11], 0
  ds_read_b128 v[12:15], v4 offset:8192
  v_exp_f32 v63, v63
  v_exp_f32 v64, v64
  v_exp_f32 v65, v65
  v_exp_f32 v66, v66
  v_exp_f32 v67, v67
  v_exp_f32 v68, v68
  v_exp_f32 v69, v69
  v_exp_f32 v70, v70
  v_exp_f32 v71, v71
  v_smfmac_f32_32x32x32_bf16 v[92:107], v[20:23], v[60:67], v36
  s_waitcnt lgkmcnt(6)
  v_cmp_ne_u64 vcc, s[72:73], v[204:205]
  s_nop 0
  s_cbranch_vccnz L_wc31
L_wr31:
  s_waitcnt lgkmcnt(5)
  v_cmp_ne_u64 vcc, s[72:73], v[202:203]
  s_nop 0
  s_cbranch_vccnz L_wc33
L_wr33:
  s_add_u32 s22, s20, 0
  s_mov_b32 m0, s22
  s_add_u32 s22, s21, 45056
  buffer_load_dwordx4 v1, s[32:35], s22 offen offset:0 sc1 lds
  buffer_load_dwordx4 v1, s[32:35], s22 offen offset:1024 sc1 lds
  v_exp_f32 v72, v72
  v_exp_f32 v73, v73
  v_exp_f32 v74, v74
  v_exp_f32 v75, v75
  s_setprio 1
  v_exp_f32 v76, v76
  v_exp_f32 v77, v77
  v_smfmac_f32_32x32x32_bf16 v[92:107], v[24:27], v[68:75], v36
  v_exp_f32 v78, v78
  s_waitcnt lgkmcnt(0)
  v_mfma_f32_32x32x16_bf16 v[60:75], v[12:15], v[8:11], 0
  ds_read_b128 v[16:19], v4 offset:9216
  v_exp_f32 v79, v79
  v_exp_f32 v80, v80
  v_exp_f32 v81, v81
  v_exp_f32 v82, v82
  v_exp_f32 v83, v83
  v_exp_f32 v84, v84
  v_exp_f32 v85, v85
  v_exp_f32 v86, v86
  v_exp_f32 v87, v87
  v_smfmac_f32_32x32x32_bf16 v[92:107], v[28:31], v[76:83], v36
  buffer_load_dwordx4 v1, s[32:35], s22 offen offset:2048 sc1 lds
  buffer_load_dwordx4 v1, s[32:35], s22 offen offset:3072 sc1 lds
  v_exp_f32 v88, v88
  v_exp_f32 v89, v89
  v_exp_f32 v90, v90
  v_exp_f32 v91, v91
  v_exp_f32 v60, v60
  v_exp_f32 v61, v61
  v_smfmac_f32_32x32x32_bf16 v[92:107], v[32:35], v[84:91], v36
  s_mov_b64 exec, s[30:31]
  ds_read_b128 v[20:23], v3 offset:9216
  ds_read_b128 v[24:27], v3 offset:9728
  ds_read_b128 v[28:31], v3 offset:10240
  ds_read_b128 v[32:35], v3 offset:10752
  s_mov_b64 exec, -1
  v_exp_f32 v62, v62
  s_waitcnt lgkmcnt(4)
  v_mfma_f32_32x32x16_bf16 v[76:91], v[16:19], v[8:11], 0
  ds_read_b128 v[12:15], v4 offset:10240
  v_exp_f32 v63, v63
  v_exp_f32 v64, v64
  v_exp_f32 v65, v65
  v_exp_f32 v66, v66
  v_exp_f32 v67, v67
  v_exp_f32 v68, v68
  v_exp_f32 v69, v69
  v_exp_f32 v70, v70
  v_exp_f32 v71, v71
  v_smfmac_f32_32x32x32_bf16 v[92:107], v[56:59], v[60:67], v36
  s_add_u32 s22, s20, 4096
  s_mov_b32 m0, s22
  s_add_u32 s22, s21, 49152
  buffer_load_dwordx4 v1, s[32:35], s22 offen offset:0 sc1 lds
  s_add_u32 s22, s20, 20480
  s_mov_b32 m0, s22
  s_add_u32 s22, s21, 109568
  buffer_load_dwordx4 v1, s[32:35], s22 offen offset:0 sc1 lds
  v_exp_f32 v72, v72
  v_exp_f32 v73, v73
  v_exp_f32 v74, v74
  v_exp_f32 v75, v75
  v_exp_f32 v76, v76
  v_exp_f32 v77, v77
  v_smfmac_f32_32x32x32_bf16 v[92:107], v[248:251], v[68:75], v36
  v_exp_f32 v78, v78
  s_waitcnt lgkmcnt(0)
  v_mfma_f32_32x32x16_bf16 v[60:75], v[12:15], v[8:11], 0
  ds_read_b128 v[16:19], v4 offset:11264
  v_exp_f32 v79, v79
  v_exp_f32 v80, v80
  v_exp_f32 v81, v81
  v_exp_f32 v82, v82
  v_exp_f32 v83, v83
  v_exp_f32 v84, v84
  v_exp_f32 v85, v85
  v_exp_f32 v86, v86
  v_exp_f32 v87, v87
  v_smfmac_f32_32x32x32_bf16 v[92:107], v[20:23], v[76:83], v36
  buffer_load_dwordx4 v1, s[32:35], s22 offen offset:1024 sc1 lds
  buffer_load_dwordx4 v1, s[32:35], s22 offen offset:2048 sc1 lds
  v_exp_f32 v88, v88
  v_exp_f32 v89, v89
  v_exp_f32 v90, v90
  v_exp_f32 v91, v91
  s_setprio 0
  v_exp_f32 v60, v60
  v_exp_f32 v61, v61
  v_smfmac_f32_32x32x32_bf16 v[92:107], v[24:27], v[84:91], v36
  s_mov_b64 exec, s[30:31]
  ds_read_b128 v[56:59], v253 offset:0
  ds_read_b128 v[248:251], v253 offset:512
  ds_read_b128 v[20:23], v253 offset:1024
  ds_read_b128 v[24:27], v253 offset:1536
  s_mov_b64 exec, -1
  v_exp_f32 v62, v62
  s_waitcnt lgkmcnt(4)
  v_mfma_f32_32x32x16_bf16 v[76:91], v[16:19], v[8:11], 0
  ds_read_b128 v[12:15], v4 offset:32768
  v_exp_f32 v63, v63
  v_exp_f32 v64, v64
  v_exp_f32 v65, v65
  v_exp_f32 v66, v66
  v_exp_f32 v67, v67
  v_exp_f32 v68, v68
  v_exp_f32 v69, v69
  v_exp_f32 v70, v70
  v_exp_f32 v71, v71
  v_smfmac_f32_32x32x32_bf16 v[92:107], v[28:31], v[60:67], v36
  buffer_load_dwordx4 v1, s[32:35], s22 offen offset:3072 sc1 lds
  s_add_u32 s22, s20, 24576
  s_mov_b32 m0, s22
  s_add_u32 s22, s21, 113664
  buffer_load_dwordx4 v1, s[32:35], s22 offen offset:0 sc1 lds
  v_exp_f32 v72, v72
  v_exp_f32 v73, v73
  v_exp_f32 v74, v74
  v_exp_f32 v75, v75
  v_exp_f32 v76, v76
  v_exp_f32 v77, v77
  v_smfmac_f32_32x32x32_bf16 v[92:107], v[32:35], v[68:75], v36
  v_exp_f32 v78, v78
  s_waitcnt lgkmcnt(0)
  v_mfma_f32_32x32x16_bf16 v[60:75], v[12:15], v[8:11], 0
  ds_read_b128 v[16:19], v4 offset:33792
  v_exp_f32 v79, v79
  v_exp_f32 v80, v80
  v_exp_f32 v81, v81
  v_exp_f32 v82, v82
  v_exp_f32 v83, v83
  v_exp_f32 v84, v84
  v_exp_f32 v85, v85
  v_exp_f32 v86, v86
  v_exp_f32 v87, v87
  v_smfmac_f32_32x32x32_bf16 v[92:107], v[56:59], v[76:83], v36
  buffer_load_dwordx4 v1, s[32:35], s22 offen offset:1024 sc1 lds
  v_exp_f32 v88, v88
  v_exp_f32 v89, v89
  v_exp_f32 v90, v90
  v_exp_f32 v91, v91
L_join:
  s_setprio 3
  v_exp_f32 v60, v60
  v_exp_f32 v61, v61
  v_smfmac_f32_32x32x32_bf16 v[92:107], v[248:251], v[84:91], v36
  s_mov_b64 exec, s[30:31]
  ds_read_b128 v[28:31], v253 offset:2048
  ds_read_b128 v[32:35], v253 offset:2560
  ds_read_b128 v[56:59], v253 offset:3072
  ds_read_b128 v[248:251], v253 offset:3584
  s_mov_b64 exec, -1
  v_exp_f32 v62, v62
  s_waitcnt lgkmcnt(4)
  v_mfma_f32_32x32x16_bf16 v[76:91], v[16:19], v[8:11], 0
  ds_read_b128 v[12:15], v4 offset:34816
  v_exp_f32 v63, v63
  v_exp_f32 v64, v64
  v_exp_f32 v65, v65
  v_exp_f32 v66, v66
  v_exp_f32 v67, v67
  v_exp_f32 v68, v68
  v_exp_f32 v69, v69
  v_exp_f32 v70, v70
  v_exp_f32 v71, v71
  v_smfmac_f32_32x32x32_bf16 v[92:107], v[20:23], v[60:67], v36
  v_exp_f32 v72, v72
  v_exp_f32 v73, v73
  v_exp_f32 v74, v74
  v_exp_f32 v75, v75
  v_exp_f32 v76, v76
  v_exp_f32 v77, v77
  v_smfmac_f32_32x32x32_bf16 v[92:107], v[24:27], v[68:75], v36
  v_exp_f32 v78, v78
  s_waitcnt lgkmcnt(0)
  v_mfma_f32_32x32x16_bf16 v[60:75], v[12:15], v[8:11], 0
  ds_read_b128 v[16:19], v4 offset:35840
  v_exp_f32 v79, v79
  v_exp_f32 v80, v80
  v_exp_f32 v81, v81
  v_exp_f32 v82, v82
  v_exp_f32 v83, v83
  v_exp_f32 v84, v84
  v_exp_f32 v85, v85
  v_exp_f32 v86, v86
  v_exp_f32 v87, v87
  v_smfmac_f32_32x32x32_bf16 v[92:107], v[28:31], v[76:83], v36
  v_exp_f32 v88, v88
  v_exp_f32 v89, v89
  v_exp_f32 v90, v90
  v_exp_f32 v91, v91
  v_exp_f32 v60, v60
  v_exp_f32 v61, v61
  v_smfmac_f32_32x32x32_bf16 v[92:107], v[32:35], v[84:91], v36
  s_mov_b64 exec, s[30:31]
  ds_read_b128 v[20:23], v253 offset:4096
  ds_read_b128 v[24:27], v253 offset:4608
  ds_read_b128 v[28:31], v253 offset:5120
  ds_read_b128 v[32:35], v253 offset:5632
  s_mov_b64 exec, -1
  v_exp_f32 v62, v62
  s_waitcnt lgkmcnt(4)
  v_mfma_f32_32x32x16_bf16 v[76:91], v[16:19], v[8:11], 0
  ds_read_b128 v[12:15], v4 offset:36864
  v_exp_f32 v63, v63
  v_exp_f32 v64, v64
  v_exp_f32 v65, v65
  v_exp_f32 v66, v66
  v_exp_f32 v67, v67
  v_exp_f32 v68, v68
  v_exp_f32 v69, v69
  v_exp_f32 v70, v70
  v_exp_f32 v71, v71
  v_smfmac_f32_32x32x32_bf16 v[92:107], v[56:59], v[60:67], v36
  v_exp_f32 v72, v72
  v_exp_f32 v73, v73
  v_exp_f32 v74, v74
  v_exp_f32 v75, v75
  v_exp_f32 v76, v76
  v_exp_f32 v77, v77
  v_smfmac_f32_32x32x32_bf16 v[92:107], v[248:251], v[68:75], v36
  v_exp_f32 v78, v78
  s_waitcnt lgkmcnt(0)
  v_mfma_f32_32x32x16_bf16 v[60:75], v[12:15], v[8:11], 0
  ds_read_b128 v[16:19], v4 offset:37888
  v_exp_f32 v79, v79
  v_exp_f32 v80, v80
  v_exp_f32 v81, v81
  v_exp_f32 v82, v82
  v_exp_f32 v83, v83
  v_exp_f32 v84, v84
  v_exp_f32 v85, v85
  v_exp_f32 v86, v86
  v_exp_f32 v87, v87
  v_smfmac_f32_32x32x32_bf16 v[92:107], v[20:23], v[76:83], v36
  v_exp_f32 v88, v88
  v_exp_f32 v89, v89
  v_exp_f32 v90, v90
  v_exp_f32 v91, v91
  v_exp_f32 v60, v60
  v_exp_f32 v61, v61
  v_smfmac_f32_32x32x32_bf16 v[92:107], v[24:27], v[84:91], v36
  s_mov_b64 exec, s[30:31]
  ds_read_b128 v[56:59], v253 offset:6144
  ds_read_b128 v[248:251], v253 offset:6656
  ds_read_b128 v[20:23], v253 offset:7168
  ds_read_b128 v[24:27], v253 offset:7680
  s_mov_b64 exec, -1
  v_exp_f32 v62, v62
  s_waitcnt lgkmcnt(4)
  v_mfma_f32_32x32x16_bf16 v[76:91], v[16:19], v[8:11], 0
  ds_read_b128 v[12:15], v4 offset:38912
  v_exp_f32 v63, v63
  v_exp_f32 v64, v64
  v_exp_f32 v65, v65
  v_exp_f32 v66, v66
  v_exp_f32 v67, v67
  v_exp_f32 v68, v68
  v_exp_f32 v69, v69
  v_exp_f32 v70, v70
  v_exp_f32 v71, v71
  v_smfmac_f32_32x32x32_bf16 v[92:107], v[28:31], v[60:67], v36
  v_exp_f32 v72, v72
  v_exp_f32 v73, v73
  v_exp_f32 v74, v74
  v_exp_f32 v75, v75
  v_exp_f32 v76, v76
  v_exp_f32 v77, v77
  v_smfmac_f32_32x32x32_bf16 v[92:107], v[32:35], v[68:75], v36
  v_exp_f32 v78, v78
  s_waitcnt lgkmcnt(0)
  v_mfma_f32_32x32x16_bf16 v[60:75], v[12:15], v[8:11], 0
  ds_read_b128 v[16:19], v4 offset:39936
  v_exp_f32 v79, v79
  v_exp_f32 v80, v80
  v_exp_f32 v81, v81
  v_exp_f32 v82, v82
  v_exp_f32 v83, v83
  v_exp_f32 v84, v84
  v_exp_f32 v85, v85
  v_exp_f32 v86, v86
  v_exp_f32 v87, v87
  v_smfmac_f32_32x32x32_bf16 v[92:107], v[56:59], v[76:83], v36
  s_lshr_b32 s15, s48, 1
  s_lshl_b32 s15, s15, 14
  s_add_u32 s15, s15, 262144
  s_mul_i32 s16, s27, 28
  s_add_u32 s16, s16, 32
  v_add_u32 v252, s16, v2
  v_and_b32 v252, 127, v252
  v_lshlrev_b32 v252, 7, v252
  v_add_u32 v252, s15, v252
  v_lshlrev_b32 v7, 7, v2
  s_lshl_b32 s16, s27, 10
  s_add_u32 s15, s15, s16
  s_sub_u32 s15, s15, 3584
  s_mov_b32 exec_lo, 0xf0000000
  s_mov_b32 exec_hi, 0x0000000f
  v_add_u32 v252, s15, v7
  s_lshl_b32 s15, s18, 11
  s_add_u32 s15, s15, 126464
  s_mov_b32 exec_lo, 0
  s_mov_b32 exec_hi, 0x000ffff0
  v_add_u32 v252, s15, v7
  s_mov_b64 exec, -1
  s_lshl_b32 s15, s18, 7
  s_add_u32 s15, s15, 655360
  v_writelane_b32 v252, s15, 52
  s_lshl_b32 s15, s57, 7
  s_add_u32 s15, s15, 655360
  v_writelane_b32 v252, s15, 53
  s_lshl_b32 s15, s57, 11
  s_lshr_b32 s16, s56, 1
  s_lshl_b32 s16, s16, 7
  s_add_u32 s15, s15, s16
  s_add_u32 s15, s15, 131072
  v_writelane_b32 v252, s15, 54

  v_exp_f32 v88, v88
  v_exp_f32 v89, v89
  v_exp_f32 v90, v90
  v_exp_f32 v91, v91
  v_exp_f32 v60, v60
  v_exp_f32 v61, v61
  v_smfmac_f32_32x32x32_bf16 v[92:107], v[248:251], v[84:91], v36
  s_mov_b64 exec, s[30:31]
  ds_read_b128 v[28:31], v253 offset:8192
  ds_read_b128 v[32:35], v253 offset:8704
  ds_read_b128 v[56:59], v253 offset:9216
  ds_read_b128 v[248:251], v253 offset:9728
  s_mov_b64 exec, -1
  v_exp_f32 v62, v62
  s_waitcnt lgkmcnt(4)
  v_mfma_f32_32x32x16_bf16 v[76:91], v[16:19], v[8:11], 0
  ds_read_b128 v[12:15], v4 offset:40960
  v_exp_f32 v63, v63
  v_exp_f32 v64, v64
  v_exp_f32 v65, v65
  v_exp_f32 v66, v66
  v_exp_f32 v67, v67
  v_exp_f32 v68, v68
  v_exp_f32 v69, v69
  v_exp_f32 v70, v70
  v_exp_f32 v71, v71
  v_smfmac_f32_32x32x32_bf16 v[92:107], v[20:23], v[60:67], v36
  v_exp_f32 v72, v72
  v_exp_f32 v73, v73
  v_exp_f32 v74, v74
  v_exp_f32 v75, v75
  v_exp_f32 v76, v76
  v_exp_f32 v77, v77
  v_smfmac_f32_32x32x32_bf16 v[92:107], v[24:27], v[68:75], v36
  v_exp_f32 v78, v78
  s_waitcnt lgkmcnt(0)
  v_mfma_f32_32x32x16_bf16 v[60:75], v[12:15], v[8:11], 0
  ds_read_b128 v[16:19], v4 offset:41984
  v_exp_f32 v79, v79
  v_exp_f32 v80, v80
  v_exp_f32 v81, v81
  v_exp_f32 v82, v82
  v_exp_f32 v83, v83
  v_exp_f32 v84, v84
  v_exp_f32 v85, v85
  v_exp_f32 v86, v86
  v_exp_f32 v87, v87
  v_smfmac_f32_32x32x32_bf16 v[92:107], v[28:31], v[76:83], v36
  s_mov_b32 s16, 25165824
  s_mov_b32 s4, -1
  s_mov_b32 s5, 0x007fffff
  s_mov_b64 exec, s[4:5]
  buffer_load_dwordx2 v[246:247], v252, s[32:35], s16 offen sc1
  s_mov_b64 exec, -1

  v_exp_f32 v88, v88
  v_exp_f32 v89, v89
  v_exp_f32 v90, v90
  v_exp_f32 v91, v91
  v_exp_f32 v60, v60
  v_exp_f32 v61, v61
  v_smfmac_f32_32x32x32_bf16 v[92:107], v[32:35], v[84:91], v36
  v_subrev_u32 v3, 57344, v3
  s_mov_b64 exec, s[30:31]
  ds_read_b128 v[20:23], v253 offset:10240
  ds_read_b128 v[24:27], v253 offset:10752
  ds_read_b128 v[28:31], v253 offset:11264
  ds_read_b128 v[32:35], v253 offset:11776
  s_mov_b64 exec, -1
  v_exp_f32 v62, v62
  s_waitcnt lgkmcnt(4)
  v_mfma_f32_32x32x16_bf16 v[76:91], v[16:19], v[8:11], 0
  ds_read_b128 v[12:15], v4 offset:43008
  v_exp_f32 v63, v63
  v_exp_f32 v64, v64
  v_exp_f32 v65, v65
  v_exp_f32 v66, v66
  v_exp_f32 v67, v67
  v_exp_f32 v68, v68
  v_exp_f32 v69, v69
  v_exp_f32 v70, v70
  v_exp_f32 v71, v71
  v_smfmac_f32_32x32x32_bf16 v[92:107], v[56:59], v[60:67], v36
  v_exp_f32 v72, v72
  v_exp_f32 v73, v73
  v_exp_f32 v74, v74
  v_exp_f32 v75, v75
  v_exp_f32 v76, v76
  v_exp_f32 v77, v77
  v_smfmac_f32_32x32x32_bf16 v[92:107], v[248:251], v[68:75], v36
  v_exp_f32 v78, v78
  s_waitcnt lgkmcnt(0)
  v_mfma_f32_32x32x16_bf16 v[60:75], v[12:15], v[8:11], 0
  ds_read_b128 v[16:19], v4 offset:44032
  v_exp_f32 v79, v79
  v_exp_f32 v80, v80
  v_exp_f32 v81, v81
  v_exp_f32 v82, v82
  v_exp_f32 v83, v83
  v_exp_f32 v84, v84
  v_exp_f32 v85, v85
  v_exp_f32 v86, v86
  v_exp_f32 v87, v87
  v_smfmac_f32_32x32x32_bf16 v[92:107], v[20:23], v[76:83], v36
  s_waitcnt vmcnt(0)
  s_mov_b64 exec, s[4:5]
  v_cmp_ne_u64 vcc, s[72:73], v[246:247]
  s_mov_b64 exec, -1
  s_nop 0
  s_cbranch_vccnz L_pslow
L_pok:
  v_and_b32 v252, 31, v2
  v_lshlrev_b32 v252, 2, v252
  s_lshl_b32 s15, s18, 7
  s_add_u32 s15, s15, 20971520
  s_lshl_b32 s16, s57, 7
  s_add_u32 s16, s16, 20971520

  v_lshrrev_b32 v246, 3, v2
  v_lshlrev_b32 v246, 2, v246
  v_lshl_add_u32 v246, s27, 5, v246

  buffer_load_dwordx4 v[44:47], v1, s[32:35], s24 offen offset:0
  buffer_load_dwordx4 v[52:55], v1, s[32:35], s26 offen offset:0 sc1
  buffer_load_dwordx4 v[48:51], v1, s[32:35], s25 offen offset:0
  v_exp_f32 v88, v88
  v_exp_f32 v89, v89
  v_exp_f32 v90, v90
  v_exp_f32 v91, v91
  v_exp_f32 v60, v60
  v_exp_f32 v61, v61
  v_smfmac_f32_32x32x32_bf16 v[92:107], v[24:27], v[84:91], v36
  s_mov_b64 exec, s[30:31]
  ds_read_b128 v[56:59], v253 offset:12288
  ds_read_b128 v[248:251], v253 offset:12800
  ds_read_b128 v[20:23], v253 offset:13312
  ds_read_b128 v[24:27], v253 offset:13824
  s_mov_b64 exec, -1
  v_exp_f32 v62, v62
  s_waitcnt lgkmcnt(4)
  v_mfma_f32_32x32x16_bf16 v[76:91], v[16:19], v[8:11], 0
  ds_read_b128 v[12:15], v4 offset:45056
  v_exp_f32 v63, v63
  v_exp_f32 v64, v64
  v_exp_f32 v65, v65
  v_exp_f32 v66, v66
  v_exp_f32 v67, v67
  v_exp_f32 v68, v68
  v_exp_f32 v69, v69
  v_exp_f32 v70, v70
  v_exp_f32 v71, v71
  v_smfmac_f32_32x32x32_bf16 v[92:107], v[28:31], v[60:67], v36
  buffer_load_dwordx4 v[152:155], v1, s[32:35], s24 offen offset:1024
  buffer_load_dwordx4 v[160:163], v1, s[32:35], s26 offen offset:1024 sc1
  buffer_load_dwordx4 v[156:159], v1, s[32:35], s25 offen offset:1024
  v_exp_f32 v72, v72
  v_exp_f32 v73, v73
  v_exp_f32 v74, v74
  v_exp_f32 v75, v75
  v_exp_f32 v76, v76
  v_exp_f32 v77, v77
  v_smfmac_f32_32x32x32_bf16 v[92:107], v[32:35], v[68:75], v36
  v_exp_f32 v78, v78
  s_waitcnt lgkmcnt(0)
  v_mfma_f32_32x32x16_bf16 v[60:75], v[12:15], v[8:11], 0
  ds_read_b128 v[16:19], v4 offset:46080
  v_exp_f32 v79, v79
  v_exp_f32 v80, v80
  v_exp_f32 v81, v81
  v_exp_f32 v82, v82
  v_exp_f32 v83, v83
  v_exp_f32 v84, v84
  v_exp_f32 v85, v85
  v_exp_f32 v86, v86
  v_exp_f32 v87, v87
  v_smfmac_f32_32x32x32_bf16 v[92:107], v[56:59], v[76:83], v36
  buffer_load_dwordx4 v[164:167], v1, s[32:35], s24 offen offset:2048
  buffer_load_dwordx4 v[172:175], v1, s[32:35], s26 offen offset:2048 sc1
  buffer_load_dwordx4 v[168:171], v1, s[32:35], s25 offen offset:2048
  v_exp_f32 v88, v88
  v_exp_f32 v89, v89
  v_exp_f32 v90, v90
  v_exp_f32 v91, v91
  v_exp_f32 v60, v60
  v_exp_f32 v61, v61
  v_smfmac_f32_32x32x32_bf16 v[92:107], v[248:251], v[84:91], v36
  s_mov_b64 exec, s[30:31]
  ds_read_b128 v[28:31], v253 offset:14336
  ds_read_b128 v[32:35], v253 offset:14848
  ds_read_b128 v[56:59], v253 offset:15360
  ds_read_b128 v[248:251], v253 offset:15872
  s_mov_b64 exec, -1
  v_exp_f32 v62, v62
  s_waitcnt lgkmcnt(4)
  v_mfma_f32_32x32x16_bf16 v[76:91], v[16:19], v[8:11], 0
  ds_read_b128 v[12:15], v4 offset:47104
  v_exp_f32 v63, v63
  v_exp_f32 v64, v64
  v_exp_f32 v65, v65
  v_exp_f32 v66, v66
  v_exp_f32 v67, v67
  s_waitcnt vmcnt(7)
  v_mfma_f32_32x32x16_bf16 v[108:123], v[44:47], v[52:55], 0
  buffer_load_dwordx4 v[140:143], v1, s[32:35], s24 offen offset:3072
  s_add_u32 s24, s24, 4096
  v_exp_f32 v68, v68
  v_exp_f32 v69, v69
  v_exp_f32 v70, v70
  v_exp_f32 v71, v71
  v_smfmac_f32_32x32x32_bf16 v[92:107], v[20:23], v[60:67], v36
  buffer_load_dwordx4 v[148:151], v1, s[32:35], s26 offen offset:3072 sc1
  s_add_u32 s26, s26, 4096
  buffer_load_dword v241, v246, s[32:35], s15 offen sc1
  buffer_load_dword v240, v252, s[32:35], s16 offen sc1
  v_exp_f32 v72, v72
  v_exp_f32 v73, v73
  v_exp_f32 v74, v74
  s_waitcnt vmcnt(10)
  v_mfma_f32_32x32x16_bf16 v[124:139], v[48:51], v[52:55], 0
  buffer_load_dwordx4 v[144:147], v1, s[32:35], s25 offen offset:3072
  s_add_u32 s25, s25, 4096
  v_exp_f32 v75, v75
  v_exp_f32 v76, v76
  v_exp_f32 v77, v77
  v_smfmac_f32_32x32x32_bf16 v[92:107], v[24:27], v[68:75], v36
  v_exp_f32 v78, v78
  s_waitcnt lgkmcnt(0)
  v_mfma_f32_32x32x16_bf16 v[60:75], v[12:15], v[8:11], 0
  ds_read_b128 v[16:19], v4 offset:48128
  v_exp_f32 v79, v79
  v_exp_f32 v80, v80
  v_exp_f32 v81, v81
  v_exp_f32 v82, v82
  v_exp_f32 v83, v83
  s_waitcnt vmcnt(9)
  v_mfma_f32_32x32x16_bf16 v[108:123], v[152:155], v[160:163], v[108:123]
  buffer_load_dwordx4 v[44:47], v1, s[32:35], s24 offen offset:0
  v_exp_f32 v84, v84
  v_exp_f32 v85, v85
  v_exp_f32 v86, v86
  v_exp_f32 v87, v87
  v_smfmac_f32_32x32x32_bf16 v[92:107], v[28:31], v[76:83], v36
  buffer_load_dwordx4 v[52:55], v1, s[32:35], s26 offen offset:0 sc1
  v_exp_f32 v88, v88
  v_exp_f32 v89, v89
  v_exp_f32 v90, v90
  v_exp_f32 v91, v91
  s_setprio 2
  v_exp_f32 v60, v60
  v_exp_f32 v61, v61
  v_smfmac_f32_32x32x32_bf16 v[92:107], v[32:35], v[84:91], v36
  s_mov_b64 exec, s[30:31]
  ds_read_b128 v[20:23], v253 offset:16384
  ds_read_b128 v[24:27], v253 offset:16896
  ds_read_b128 v[28:31], v253 offset:17408
  ds_read_b128 v[32:35], v253 offset:17920
  s_mov_b64 exec, -1
  v_exp_f32 v62, v62
  s_waitcnt lgkmcnt(4)
  v_mfma_f32_32x32x16_bf16 v[76:91], v[16:19], v[8:11], 0
  ds_read_b128 v[12:15], v4 offset:49152
  v_exp_f32 v63, v63
  v_exp_f32 v64, v64
  v_exp_f32 v65, v65
  v_exp_f32 v66, v66
  v_exp_f32 v67, v67
  s_waitcnt vmcnt(10)
  v_mfma_f32_32x32x16_bf16 v[124:139], v[156:159], v[160:163], v[124:139]
  buffer_load_dwordx4 v[48:51], v1, s[32:35], s25 offen offset:0
  v_exp_f32 v68, v68
  v_exp_f32 v69, v69
  v_exp_f32 v70, v70
  v_exp_f32 v71, v71
  v_smfmac_f32_32x32x32_bf16 v[92:107], v[56:59], v[60:67], v36
  buffer_load_dwordx4 v[152:155], v1, s[32:35], s24 offen offset:1024
  v_exp_f32 v72, v72
  v_exp_f32 v73, v73
  v_exp_f32 v74, v74
  v_exp_f32 v75, v75
  v_exp_f32 v76, v76
  v_exp_f32 v77, v77
  v_smfmac_f32_32x32x32_bf16 v[92:107], v[248:251], v[68:75], v36
  v_exp_f32 v78, v78
  s_waitcnt lgkmcnt(0)
  v_mfma_f32_32x32x16_bf16 v[60:75], v[12:15], v[8:11], 0
  ds_read_b128 v[16:19], v4 offset:50176
  v_exp_f32 v79, v79
  v_exp_f32 v80, v80
  v_exp_f32 v81, v81
  v_exp_f32 v82, v82
  v_exp_f32 v83, v83
  s_waitcnt vmcnt(10)
  v_mfma_f32_32x32x16_bf16 v[108:123], v[164:167], v[172:175], v[108:123]
  buffer_load_dwordx4 v[160:163], v1, s[32:35], s26 offen offset:1024 sc1
  v_exp_f32 v84, v84
  v_exp_f32 v85, v85
  v_exp_f32 v86, v86
  v_exp_f32 v87, v87
  v_smfmac_f32_32x32x32_bf16 v[92:107], v[20:23], v[76:83], v36
  buffer_load_dwordx4 v[156:159], v1, s[32:35], s25 offen offset:1024
  v_exp_f32 v88, v88
  v_exp_f32 v89, v89
  v_exp_f32 v90, v90
  v_exp_f32 v91, v91
  v_exp_f32 v60, v60
  v_exp_f32 v61, v61
  v_smfmac_f32_32x32x32_bf16 v[92:107], v[24:27], v[84:91], v36
  s_mov_b64 exec, s[30:31]
  ds_read_b128 v[56:59], v253 offset:18432
  ds_read_b128 v[248:251], v253 offset:18944
  ds_read_b128 v[20:23], v253 offset:19456
  ds_read_b128 v[24:27], v253 offset:19968
  s_mov_b64 exec, -1
  v_exp_f32 v62, v62
  s_waitcnt lgkmcnt(4)
  v_mfma_f32_32x32x16_bf16 v[76:91], v[16:19], v[8:11], 0
  ds_read_b128 v[12:15], v4 offset:51200
  v_exp_f32 v63, v63
  v_exp_f32 v64, v64
  v_exp_f32 v65, v65
  v_exp_f32 v66, v66
  v_exp_f32 v67, v67
  s_waitcnt vmcnt(11)
  v_mfma_f32_32x32x16_bf16 v[124:139], v[168:171], v[172:175], v[124:139]
  buffer_load_dwordx4 v[164:167], v1, s[32:35], s24 offen offset:2048
  v_exp_f32 v68, v68
  v_exp_f32 v69, v69
  v_exp_f32 v70, v70
  v_exp_f32 v71, v71
  v_smfmac_f32_32x32x32_bf16 v[92:107], v[28:31], v[60:67], v36
  buffer_load_dwordx4 v[172:175], v1, s[32:35], s26 offen offset:2048 sc1
  buffer_load_dwordx4 v[176:179], v1, s[32:35], s28 offen offset:0
  v_exp_f32 v72, v72
  v_exp_f32 v73, v73
  v_exp_f32 v74, v74
  v_exp_f32 v75, v75
  v_exp_f32 v76, v76
  v_exp_f32 v77, v77
  v_smfmac_f32_32x32x32_bf16 v[92:107], v[32:35], v[68:75], v36
  v_exp_f32 v78, v78
  s_waitcnt lgkmcnt(0)
  v_mfma_f32_32x32x16_bf16 v[60:75], v[12:15], v[8:11], 0
  ds_read_b128 v[16:19], v4 offset:52224
  v_exp_f32 v79, v79
  v_exp_f32 v80, v80
  v_exp_f32 v81, v81
  v_exp_f32 v82, v82
  v_exp_f32 v83, v83
  s_waitcnt vmcnt(12)
  v_mfma_f32_32x32x16_bf16 v[108:123], v[140:143], v[148:151], v[108:123]
  buffer_load_dwordx4 v[168:171], v1, s[32:35], s25 offen offset:2048
  v_exp_f32 v84, v84
  v_exp_f32 v85, v85
  v_exp_f32 v86, v86
  v_exp_f32 v87, v87
  v_smfmac_f32_32x32x32_bf16 v[92:107], v[56:59], v[76:83], v36
  buffer_load_dwordx4 v[140:143], v1, s[32:35], s24 offen offset:3072
  s_add_u32 s24, s24, 4096
  v_exp_f32 v88, v88
  v_exp_f32 v89, v89
  v_exp_f32 v90, v90
  s_waitcnt vmcnt(11)
  v_mfma_f32_32x32x16_bf16 v[124:139], v[144:147], v[148:151], v[124:139]
  buffer_load_dwordx4 v[148:151], v1, s[32:35], s26 offen offset:3072 sc1
  s_add_u32 s26, s26, 4096
  v_exp_f32 v91, v91
  v_exp_f32 v60, v60
  v_exp_f32 v61, v61
  v_smfmac_f32_32x32x32_bf16 v[92:107], v[248:251], v[84:91], v36
  s_mov_b64 exec, s[30:31]
  ds_read_b128 v[28:31], v253 offset:20480
  ds_read_b128 v[32:35], v253 offset:20992
  ds_read_b128 v[56:59], v253 offset:21504
  ds_read_b128 v[248:251], v253 offset:22016
  s_mov_b64 exec, -1
  v_exp_f32 v62, v62
  s_waitcnt lgkmcnt(4)
  v_mfma_f32_32x32x16_bf16 v[76:91], v[16:19], v[8:11], 0
  ds_read_b128 v[12:15], v4 offset:53248
  v_exp_f32 v63, v63
  v_exp_f32 v64, v64
  v_exp_f32 v65, v65
  v_exp_f32 v66, v66
  v_exp_f32 v67, v67
  s_waitcnt vmcnt(10)
  v_mfma_f32_32x32x16_bf16 v[108:123], v[44:47], v[52:55], v[108:123]
  buffer_load_dwordx4 v[144:147], v1, s[32:35], s25 offen offset:3072
  s_add_u32 s25, s25, 4096
  v_exp_f32 v68, v68
  v_exp_f32 v69, v69
  v_exp_f32 v70, v70
  v_exp_f32 v71, v71
  v_smfmac_f32_32x32x32_bf16 v[92:107], v[20:23], v[60:67], v36
  buffer_load_dwordx4 v[44:47], v1, s[32:35], s24 offen offset:0
  buffer_load_dwordx4 v[180:183], v1, s[32:35], s28 offen offset:1024
  v_exp_f32 v72, v72
  v_exp_f32 v73, v73
  v_exp_f32 v74, v74
  v_exp_f32 v75, v75
  v_exp_f32 v76, v76
  v_exp_f32 v77, v77
  v_smfmac_f32_32x32x32_bf16 v[92:107], v[24:27], v[68:75], v36
  v_exp_f32 v78, v78
  s_waitcnt lgkmcnt(0)
  v_mfma_f32_32x32x16_bf16 v[60:75], v[12:15], v[8:11], 0
  ds_read_b128 v[16:19], v4 offset:54272
  v_exp_f32 v79, v79
  v_exp_f32 v80, v80
  v_exp_f32 v81, v81
  v_exp_f32 v82, v82
  v_exp_f32 v83, v83
  s_waitcnt vmcnt(12)
  v_mfma_f32_32x32x16_bf16 v[124:139], v[48:51], v[52:55], v[124:139]
  buffer_load_dwordx4 v[52:55], v1, s[32:35], s26 offen offset:0 sc1
  v_exp_f32 v84, v84
  v_exp_f32 v85, v85
  v_exp_f32 v86, v86
  v_exp_f32 v87, v87
  v_smfmac_f32_32x32x32_bf16 v[92:107], v[28:31], v[76:83], v36
  buffer_load_dwordx4 v[48:51], v1, s[32:35], s25 offen offset:0
  v_exp_f32 v88, v88
  v_exp_f32 v89, v89
  v_exp_f32 v90, v90
  v_exp_f32 v91, v91
  v_exp_f32 v60, v60
  v_exp_f32 v61, v61
  v_smfmac_f32_32x32x32_bf16 v[92:107], v[32:35], v[84:91], v36
  s_mov_b64 exec, s[30:31]
  ds_read_b128 v[20:23], v253 offset:22528
  ds_read_b128 v[24:27], v253 offset:23040
  ds_read_b128 v[28:31], v253 offset:23552
  ds_read_b128 v[32:35], v253 offset:24064
  s_mov_b64 exec, -1
  v_exp_f32 v62, v62
  s_waitcnt lgkmcnt(4)
  v_mfma_f32_32x32x16_bf16 v[76:91], v[16:19], v[8:11], 0
  ds_read_b128 v[12:15], v4 offset:55296
  v_exp_f32 v63, v63
  v_exp_f32 v64, v64
  v_exp_f32 v65, v65
  v_exp_f32 v66, v66
  v_exp_f32 v67, v67
  s_waitcnt vmcnt(12)
  v_mfma_f32_32x32x16_bf16 v[108:123], v[152:155], v[160:163], v[108:123]
  buffer_load_dwordx4 v[152:155], v1, s[32:35], s24 offen offset:1024
  v_exp_f32 v68, v68
  v_exp_f32 v69, v69
  v_exp_f32 v70, v70
  v_exp_f32 v71, v71
  v_smfmac_f32_32x32x32_bf16 v[92:107], v[56:59], v[60:67], v36
  buffer_load_dwordx4 v[184:187], v1, s[32:35], s28 offen offset:2048
  v_exp_f32 v72, v72
  v_exp_f32 v73, v73
  v_exp_f32 v74, v74
  v_exp_f32 v75, v75
  v_exp_f32 v76, v76
  v_exp_f32 v77, v77
  v_smfmac_f32_32x32x32_bf16 v[92:107], v[248:251], v[68:75], v36
  v_exp_f32 v78, v78
  s_waitcnt lgkmcnt(0)
  v_mfma_f32_32x32x16_bf16 v[60:75], v[12:15], v[8:11], 0
  ds_read_b128 v[16:19], v4 offset:56320
  v_exp_f32 v79, v79
  v_exp_f32 v80, v80
  v_exp_f32 v81, v81
  v_exp_f32 v82, v82
  v_exp_f32 v83, v83
  s_waitcnt vmcnt(13)
  v_mfma_f32_32x32x16_bf16 v[124:139], v[156:159], v[160:163], v[124:139]
  buffer_load_dwordx4 v[160:163], v1, s[32:35], s26 offen offset:1024 sc1
  v_exp_f32 v84, v84
  v_exp_f32 v85, v85
  v_exp_f32 v86, v86
  v_exp_f32 v87, v87
  v_smfmac_f32_32x32x32_bf16 v[92:107], v[20:23], v[76:83], v36
  buffer_load_dwordx4 v[156:159], v1, s[32:35], s25 offen offset:1024
  v_exp_f32 v88, v88
  v_exp_f32 v89, v89
  v_exp_f32 v90, v90
  v_exp_f32 v91, v91
  v_exp_f32 v60, v60
  v_exp_f32 v61, v61
  v_smfmac_f32_32x32x32_bf16 v[92:107], v[24:27], v[84:91], v36
  s_mov_b64 exec, s[30:31]
  ds_read_b128 v[56:59], v253 offset:24576
  ds_read_b128 v[248:251], v253 offset:25088
  ds_read_b128 v[20:23], v253 offset:25600
  ds_read_b128 v[24:27], v253 offset:26112
  s_mov_b64 exec, -1
  v_exp_f32 v62, v62
  s_waitcnt lgkmcnt(4)
  v_mfma_f32_32x32x16_bf16 v[76:91], v[16:19], v[8:11], 0
  ds_read_b128 v[12:15], v4 offset:57344
  v_exp_f32 v63, v63
  v_exp_f32 v64, v64
  v_exp_f32 v65, v65
  v_exp_f32 v66, v66
  v_exp_f32 v67, v67
  s_waitcnt vmcnt(13)
  v_mfma_f32_32x32x16_bf16 v[108:123], v[164:167], v[172:175], v[108:123]
  buffer_load_dwordx4 v[164:167], v1, s[32:35], s24 offen offset:2048
  v_exp_f32 v68, v68
  v_exp_f32 v69, v69
  v_exp_f32 v70, v70
  v_exp_f32 v71, v71
  v_smfmac_f32_32x32x32_bf16 v[92:107], v[28:31], v[60:67], v36
  buffer_load_dwordx4 v[188:191], v1, s[32:35], s28 offen offset:3072
  s_add_u32 s28, s28, 4096
  v_exp_f32 v72, v72
  v_exp_f32 v73, v73
  v_exp_f32 v74, v74
  s_waitcnt vmcnt(13)
  v_mfma_f32_32x32x16_bf16 v[124:139], v[168:171], v[172:175], v[124:139]
  buffer_load_dwordx4 v[172:175], v1, s[32:35], s26 offen offset:2048 sc1
  v_exp_f32 v75, v75
  v_exp_f32 v76, v76
  v_exp_f32 v77, v77
  v_smfmac_f32_32x32x32_bf16 v[92:107], v[32:35], v[68:75], v36
  v_exp_f32 v78, v78
  s_waitcnt lgkmcnt(0)
  v_mfma_f32_32x32x16_bf16 v[60:75], v[12:15], v[8:11], 0
  ds_read_b128 v[16:19], v4 offset:58368
  v_exp_f32 v79, v79
  v_exp_f32 v80, v80
  v_exp_f32 v81, v81
  v_exp_f32 v82, v82
  v_exp_f32 v83, v83
  s_waitcnt vmcnt(12)
  v_mfma_f32_32x32x16_bf16 v[108:123], v[140:143], v[148:151], v[108:123]
  buffer_load_dwordx4 v[168:171], v1, s[32:35], s25 offen offset:2048
  v_exp_f32 v84, v84
  v_exp_f32 v85, v85
  v_exp_f32 v86, v86
  v_exp_f32 v87, v87
  v_smfmac_f32_32x32x32_bf16 v[92:107], v[56:59], v[76:83], v36
  buffer_load_dwordx4 v[140:143], v1, s[32:35], s24 offen offset:3072
  s_add_u32 s24, s24, 4096
  v_exp_f32 v88, v88
  v_exp_f32 v89, v89
  v_exp_f32 v90, v90
  v_exp_f32 v91, v91
  s_setprio 1
  v_exp_f32 v60, v60
  v_exp_f32 v61, v61
  v_smfmac_f32_32x32x32_bf16 v[92:107], v[248:251], v[84:91], v36
  s_mov_b64 exec, s[30:31]
  ds_read_b128 v[28:31], v253 offset:26624
  ds_read_b128 v[32:35], v253 offset:27136
  ds_read_b128 v[56:59], v253 offset:27648
  ds_read_b128 v[248:251], v253 offset:28160
  s_mov_b64 exec, -1
  v_exp_f32 v62, v62
  s_waitcnt lgkmcnt(4)
  v_mfma_f32_32x32x16_bf16 v[76:91], v[16:19], v[8:11], 0
  ds_read_b128 v[12:15], v4 offset:59392
  v_exp_f32 v63, v63
  v_exp_f32 v64, v64
  v_exp_f32 v65, v65
  v_exp_f32 v66, v66
  v_exp_f32 v67, v67
  s_waitcnt vmcnt(13)
  v_mfma_f32_32x32x16_bf16 v[124:139], v[144:147], v[148:151], v[124:139]
  buffer_load_dwordx4 v[148:151], v1, s[32:35], s26 offen offset:3072 sc1
  s_add_u32 s26, s26, 4096
  v_exp_f32 v68, v68
  v_exp_f32 v69, v69
  v_exp_f32 v70, v70
  v_exp_f32 v71, v71
  v_smfmac_f32_32x32x32_bf16 v[92:107], v[20:23], v[60:67], v36
  buffer_load_dwordx4 v[144:147], v1, s[32:35], s25 offen offset:3072
  s_add_u32 s25, s25, 4096
  buffer_load_dwordx4 v[192:195], v1, s[32:35], s28 offen offset:0
  v_exp_f32 v72, v72
  v_exp_f32 v73, v73
  v_exp_f32 v74, v74
  v_exp_f32 v75, v75
  v_exp_f32 v76, v76
  v_exp_f32 v77, v77
  v_smfmac_f32_32x32x32_bf16 v[92:107], v[24:27], v[68:75], v36
  v_exp_f32 v78, v78
  s_waitcnt lgkmcnt(0)
  v_mfma_f32_32x32x16_bf16 v[60:75], v[12:15], v[8:11], 0
  ds_read_b128 v[16:19], v4 offset:60416
  v_exp_f32 v79, v79
  v_exp_f32 v80, v80
  v_exp_f32 v81, v81
  v_exp_f32 v82, v82
  v_exp_f32 v83, v83
  s_waitcnt vmcnt(13)
  v_mfma_f32_32x32x16_bf16 v[108:123], v[44:47], v[52:55], v[108:123]
  buffer_load_dwordx4 v[44:47], v1, s[32:35], s24 offen offset:0
  v_exp_f32 v84, v84
  v_exp_f32 v85, v85
  v_exp_f32 v86, v86
  v_exp_f32 v87, v87
  v_smfmac_f32_32x32x32_bf16 v[92:107], v[28:31], v[76:83], v36
  v_exp_f32 v88, v88
  v_exp_f32 v89, v89
  v_exp_f32 v90, v90
  v_exp_f32 v91, v91
  v_exp_f32 v60, v60
  v_exp_f32 v61, v61
  v_smfmac_f32_32x32x32_bf16 v[92:107], v[32:35], v[84:91], v36
  s_mov_b64 exec, s[30:31]
  ds_read_b128 v[20:23], v253 offset:28672
  ds_read_b128 v[24:27], v253 offset:29184
  ds_read_b128 v[28:31], v253 offset:29696
  ds_read_b128 v[32:35], v253 offset:30208
  s_mov_b64 exec, -1
  v_exp_f32 v62, v62
  s_waitcnt lgkmcnt(4)
  v_mfma_f32_32x32x16_bf16 v[76:91], v[16:19], v[8:11], 0
  ds_read_b128 v[12:15], v4 offset:61440
  v_exp_f32 v63, v63
  v_exp_f32 v64, v64
  v_exp_f32 v65, v65
  v_exp_f32 v66, v66
  v_exp_f32 v67, v67
  s_waitcnt vmcnt(13)
  v_mfma_f32_32x32x16_bf16 v[124:139], v[48:51], v[52:55], v[124:139]
  buffer_load_dwordx4 v[52:55], v1, s[32:35], s26 offen offset:0 sc1
  v_exp_f32 v68, v68
  v_exp_f32 v69, v69
  v_exp_f32 v70, v70
  v_exp_f32 v71, v71
  v_smfmac_f32_32x32x32_bf16 v[92:107], v[56:59], v[60:67], v36
  buffer_load_dwordx4 v[48:51], v1, s[32:35], s25 offen offset:0
  buffer_load_dwordx4 v[196:199], v1, s[32:35], s28 offen offset:1024
  v_exp_f32 v72, v72
  v_exp_f32 v73, v73
  v_exp_f32 v74, v74
  v_exp_f32 v75, v75
  v_exp_f32 v76, v76
  v_exp_f32 v77, v77
  v_smfmac_f32_32x32x32_bf16 v[92:107], v[248:251], v[68:75], v36
  v_exp_f32 v78, v78
  s_waitcnt lgkmcnt(0)
  v_mfma_f32_32x32x16_bf16 v[60:75], v[12:15], v[8:11], 0
  ds_read_b128 v[16:19], v4 offset:62464
  v_exp_f32 v79, v79
  v_exp_f32 v80, v80
  v_exp_f32 v81, v81
  v_exp_f32 v82, v82
  v_exp_f32 v83, v83
  s_waitcnt vmcnt(13)
  v_mfma_f32_32x32x16_bf16 v[108:123], v[152:155], v[160:163], v[108:123]
  buffer_load_dwordx4 v[152:155], v1, s[32:35], s24 offen offset:1024
  v_exp_f32 v84, v84
  v_exp_f32 v85, v85
  v_exp_f32 v86, v86
  v_exp_f32 v87, v87
  v_smfmac_f32_32x32x32_bf16 v[92:107], v[20:23], v[76:83], v36
  v_exp_f32 v88, v88
  v_exp_f32 v89, v89
  v_exp_f32 v90, v90
  s_waitcnt vmcnt(13)
  v_mfma_f32_32x32x16_bf16 v[124:139], v[156:159], v[160:163], v[124:139]
  buffer_load_dwordx4 v[160:163], v1, s[32:35], s26 offen offset:1024 sc1
  v_exp_f32 v91, v91
  v_exp_f32 v60, v60
  v_exp_f32 v61, v61
  v_smfmac_f32_32x32x32_bf16 v[92:107], v[24:27], v[84:91], v36
  s_mov_b64 exec, s[30:31]
  ds_read_b128 v[56:59], v253 offset:30720
  ds_read_b128 v[248:251], v253 offset:31232
  ds_read_b128 v[20:23], v253 offset:31744
  ds_read_b128 v[24:27], v253 offset:32256
  s_mov_b64 exec, -1
  v_exp_f32 v62, v62
  s_waitcnt lgkmcnt(4)
  v_mfma_f32_32x32x16_bf16 v[76:91], v[16:19], v[8:11], 0
  ds_read_b128 v[12:15], v4 offset:63488
  v_exp_f32 v63, v63
  v_exp_f32 v64, v64
  v_exp_f32 v65, v65
  v_exp_f32 v66, v66
  v_exp_f32 v67, v67
  s_waitcnt vmcnt(11)
  v_mfma_f32_32x32x16_bf16 v[108:123], v[164:167], v[172:175], v[108:123]
  buffer_load_dwordx4 v[156:159], v1, s[32:35], s25 offen offset:1024
  v_exp_f32 v68, v68
  v_exp_f32 v69, v69
  v_exp_f32 v70, v70
  v_exp_f32 v71, v71
  v_smfmac_f32_32x32x32_bf16 v[92:107], v[28:31], v[60:67], v36
  buffer_load_dwordx4 v[164:167], v1, s[32:35], s24 offen offset:2048
  buffer_load_dwordx4 v[200:203], v1, s[32:35], s28 offen offset:2048
  v_exp_f32 v72, v72
  v_exp_f32 v73, v73
  v_exp_f32 v74, v74
  v_exp_f32 v75, v75
  s_setprio 0
  v_exp_f32 v76, v76
  v_exp_f32 v77, v77
  v_smfmac_f32_32x32x32_bf16 v[92:107], v[32:35], v[68:75], v36
  v_exp_f32 v78, v78
  s_waitcnt lgkmcnt(0)
  v_mfma_f32_32x32x16_bf16 v[60:75], v[12:15], v[8:11], 0
  ds_read_b128 v[16:19], v4 offset:64512
  v_exp_f32 v79, v79
  v_exp_f32 v80, v80
  v_exp_f32 v81, v81
  v_exp_f32 v82, v82
  v_exp_f32 v83, v83
  s_waitcnt vmcnt(13)
  v_mfma_f32_32x32x16_bf16 v[124:139], v[168:171], v[172:175], v[124:139]
  buffer_load_dwordx4 v[172:175], v1, s[32:35], s26 offen offset:2048 sc1
  v_exp_f32 v84, v84
  v_exp_f32 v85, v85
  v_exp_f32 v86, v86
  v_exp_f32 v87, v87
  v_smfmac_f32_32x32x32_bf16 v[92:107], v[56:59], v[76:83], v36
  buffer_load_dwordx4 v[168:171], v1, s[32:35], s25 offen offset:2048
  v_exp_f32 v88, v88
  v_exp_f32 v89, v89
  v_exp_f32 v90, v90
  v_exp_f32 v91, v91
  s_barrier
  s_setprio 3
  v_exp_f32 v60, v60
  v_exp_f32 v61, v61
  v_smfmac_f32_32x32x32_bf16 v[92:107], v[248:251], v[84:91], v36
  s_mov_b64 exec, s[30:31]
  ds_read_b128 v[28:31], v3 offset:0
  ds_read_b128 v[32:35], v3 offset:512
  ds_read_b128 v[56:59], v3 offset:1024
  ds_read_b128 v[248:251], v3 offset:1536
  s_mov_b64 exec, -1
  v_exp_f32 v62, v62
  s_waitcnt lgkmcnt(4)
  v_mfma_f32_32x32x16_bf16 v[76:91], v[16:19], v[8:11], 0
  ds_read_b128 v[12:15], v37 offset:0
  v_exp_f32 v63, v63
  v_exp_f32 v64, v64
  v_exp_f32 v65, v65
  v_exp_f32 v66, v66
  v_exp_f32 v67, v67
  s_waitcnt vmcnt(13)
  v_mfma_f32_32x32x16_bf16 v[108:123], v[140:143], v[148:151], v[108:123]
  buffer_load_dwordx4 v[140:143], v1, s[32:35], s24 offen offset:3072
  s_add_u32 s24, s24, 4096
  v_exp_f32 v68, v68
  v_exp_f32 v69, v69
  v_exp_f32 v70, v70
  v_exp_f32 v71, v71
  v_smfmac_f32_32x32x32_bf16 v[92:107], v[20:23], v[60:67], v36
  buffer_load_dwordx4 v[204:207], v1, s[32:35], s28 offen offset:3072
  s_add_u32 s28, s28, 4096
  v_exp_f32 v72, v72
  v_exp_f32 v73, v73
  v_exp_f32 v74, v74
  v_exp_f32 v75, v75
  v_exp_f32 v76, v76
  v_exp_f32 v77, v77
  v_smfmac_f32_32x32x32_bf16 v[92:107], v[24:27], v[68:75], v36
  v_exp_f32 v78, v78
  s_waitcnt lgkmcnt(0)
  v_mfma_f32_32x32x16_bf16 v[60:75], v[12:15], v[8:11], 0
  ds_read_b128 v[16:19], v37 offset:1024
  v_exp_f32 v79, v79
  v_exp_f32 v80, v80
  v_exp_f32 v81, v81
  v_exp_f32 v82, v82
  v_exp_f32 v83, v83
  s_waitcnt vmcnt(14)
  v_mfma_f32_32x32x16_bf16 v[124:139], v[144:147], v[148:151], v[124:139]
  buffer_load_dwordx4 v[148:151], v1, s[32:35], s26 offen offset:3072 sc1
  s_add_u32 s26, s26, 4096
  v_exp_f32 v84, v84
  v_exp_f32 v85, v85
  v_exp_f32 v86, v86
  v_exp_f32 v87, v87
  v_smfmac_f32_32x32x32_bf16 v[92:107], v[28:31], v[76:83], v36
  buffer_load_dwordx4 v[144:147], v1, s[32:35], s25 offen offset:3072
  s_add_u32 s25, s25, 4096
  v_exp_f32 v88, v88
  v_exp_f32 v89, v89
  v_exp_f32 v90, v90
  v_exp_f32 v91, v91
  v_exp_f32 v60, v60
  v_exp_f32 v61, v61
  v_smfmac_f32_32x32x32_bf16 v[92:107], v[32:35], v[84:91], v36
  s_mov_b64 exec, s[30:31]
  ds_read_b128 v[20:23], v3 offset:2048
  ds_read_b128 v[24:27], v3 offset:2560
  ds_read_b128 v[28:31], v3 offset:3072
  ds_read_b128 v[32:35], v3 offset:3584
  s_mov_b64 exec, -1
  v_exp_f32 v62, v62
  s_waitcnt lgkmcnt(4)
  v_mfma_f32_32x32x16_bf16 v[76:91], v[16:19], v[8:11], 0
  ds_read_b128 v[12:15], v37 offset:2048
  v_exp_f32 v63, v63
  v_exp_f32 v64, v64
  v_exp_f32 v65, v65
  v_exp_f32 v66, v66
  v_exp_f32 v67, v67
  s_waitcnt vmcnt(13)
  v_mfma_f32_32x32x16_bf16 v[108:123], v[44:47], v[52:55], v[108:123]
  buffer_load_dwordx4 v[44:47], v1, s[32:35], s24 offen offset:0
  v_exp_f32 v68, v68
  v_exp_f32 v69, v69
  v_exp_f32 v70, v70
  v_exp_f32 v71, v71
  v_smfmac_f32_32x32x32_bf16 v[92:107], v[56:59], v[60:67], v36
  s_add_u32 s28, s28, 139264
  buffer_load_dwordx4 v[208:211], v1, s[32:35], s28 offen offset:0
  v_exp_f32 v72, v72
  v_exp_f32 v73, v73
  v_exp_f32 v74, v74
  s_waitcnt vmcnt(14)
  v_mfma_f32_32x32x16_bf16 v[124:139], v[48:51], v[52:55], v[124:139]
  buffer_load_dwordx4 v[52:55], v1, s[32:35], s26 offen offset:0 sc1
  v_exp_f32 v75, v75
  v_exp_f32 v76, v76
  v_exp_f32 v77, v77
  v_smfmac_f32_32x32x32_bf16 v[92:107], v[248:251], v[68:75], v36
  v_exp_f32 v78, v78
  s_waitcnt lgkmcnt(0)
  v_mfma_f32_32x32x16_bf16 v[60:75], v[12:15], v[8:11], 0
  ds_read_b128 v[16:19], v37 offset:3072
  v_exp_f32 v79, v79
  v_exp_f32 v80, v80
  v_exp_f32 v81, v81
  v_exp_f32 v82, v82
  v_exp_f32 v83, v83
  s_waitcnt vmcnt(12)
  v_mfma_f32_32x32x16_bf16 v[108:123], v[152:155], v[160:163], v[108:123]
  buffer_load_dwordx4 v[48:51], v1, s[32:35], s25 offen offset:0
  v_exp_f32 v84, v84
  v_exp_f32 v85, v85
  v_exp_f32 v86, v86
  v_exp_f32 v87, v87
  v_smfmac_f32_32x32x32_bf16 v[92:107], v[20:23], v[76:83], v36
  buffer_load_dwordx4 v[152:155], v1, s[32:35], s24 offen offset:1024
  v_exp_f32 v88, v88
  v_exp_f32 v89, v89
  v_exp_f32 v90, v90
  v_exp_f32 v91, v91
  v_exp_f32 v60, v60
  v_exp_f32 v61, v61
  v_smfmac_f32_32x32x32_bf16 v[92:107], v[24:27], v[84:91], v36
  s_mov_b64 exec, s[30:31]
  ds_read_b128 v[56:59], v3 offset:4096
  ds_read_b128 v[248:251], v3 offset:4608
  ds_read_b128 v[20:23], v3 offset:5120
  ds_read_b128 v[24:27], v3 offset:5632
  s_mov_b64 exec, -1
  v_exp_f32 v62, v62
  s_waitcnt lgkmcnt(4)
  v_mfma_f32_32x32x16_bf16 v[76:91], v[16:19], v[8:11], 0
  ds_read_b128 v[12:15], v37 offset:4096
  v_exp_f32 v63, v63
  v_exp_f32 v64, v64
  v_exp_f32 v65, v65
  v_exp_f32 v66, v66
  v_exp_f32 v67, v67
  s_waitcnt vmcnt(13)
  v_mfma_f32_32x32x16_bf16 v[124:139], v[156:159], v[160:163], v[124:139]
  buffer_load_dwordx4 v[160:163], v1, s[32:35], s26 offen offset:1024 sc1
  v_exp_f32 v68, v68
  v_exp_f32 v69, v69
  v_exp_f32 v70, v70
  v_exp_f32 v71, v71
  v_smfmac_f32_32x32x32_bf16 v[92:107], v[28:31], v[60:67], v36
  buffer_load_dwordx4 v[156:159], v1, s[32:35], s25 offen offset:1024
  buffer_load_dwordx4 v[212:215], v1, s[32:35], s28 offen offset:1024
  v_exp_f32 v72, v72
  v_exp_f32 v73, v73
  v_exp_f32 v74, v74
  v_exp_f32 v75, v75
  v_exp_f32 v76, v76
  v_exp_f32 v77, v77
  v_smfmac_f32_32x32x32_bf16 v[92:107], v[32:35], v[68:75], v36
  v_exp_f32 v78, v78
  s_waitcnt lgkmcnt(0)
  v_mfma_f32_32x32x16_bf16 v[60:75], v[12:15], v[8:11], 0
  ds_read_b128 v[16:19], v37 offset:5120
  v_exp_f32 v79, v79
  v_exp_f32 v80, v80
  v_exp_f32 v81, v81
  v_exp_f32 v82, v82
  v_exp_f32 v83, v83
  s_waitcnt vmcnt(13)
  v_mfma_f32_32x32x16_bf16 v[108:123], v[164:167], v[172:175], v[108:123]
  buffer_load_dwordx4 v[164:167], v1, s[32:35], s24 offen offset:2048
  v_exp_f32 v84, v84
  v_exp_f32 v85, v85
  v_exp_f32 v86, v86
  v_exp_f32 v87, v87
  v_smfmac_f32_32x32x32_bf16 v[92:107], v[56:59], v[76:83], v36
  v_exp_f32 v88, v88
  v_exp_f32 v89, v89
  v_exp_f32 v90, v90
  v_exp_f32 v91, v91
  v_exp_f32 v60, v60
  v_exp_f32 v61, v61
  v_smfmac_f32_32x32x32_bf16 v[92:107], v[248:251], v[84:91], v36
  s_mov_b64 exec, s[30:31]
  ds_read_b128 v[28:31], v3 offset:6144
  ds_read_b128 v[32:35], v3 offset:6656
  ds_read_b128 v[56:59], v3 offset:7168
  ds_read_b128 v[248:251], v3 offset:7680
  s_mov_b64 exec, -1
  v_exp_f32 v62, v62
  s_waitcnt lgkmcnt(4)
  v_mfma_f32_32x32x16_bf16 v[76:91], v[16:19], v[8:11], 0
  ds_read_b128 v[12:15], v37 offset:6144
  v_exp_f32 v63, v63
  v_exp_f32 v64, v64
  v_exp_f32 v65, v65
  v_exp_f32 v66, v66
  v_exp_f32 v67, v67
  s_waitcnt vmcnt(13)
  v_mfma_f32_32x32x16_bf16 v[124:139], v[168:171], v[172:175], v[124:139]
  buffer_load_dwordx4 v[172:175], v1, s[32:35], s26 offen offset:2048 sc1
  v_exp_f32 v68, v68
  v_exp_f32 v69, v69
  v_exp_f32 v70, v70
  v_exp_f32 v71, v71
  v_smfmac_f32_32x32x32_bf16 v[92:107], v[20:23], v[60:67], v36
  buffer_load_dwordx4 v[168:171], v1, s[32:35], s25 offen offset:2048
  buffer_load_dwordx4 v[216:219], v1, s[32:35], s28 offen offset:2048
  v_exp_f32 v72, v72
  v_exp_f32 v73, v73
  v_exp_f32 v74, v74
  v_exp_f32 v75, v75
  v_exp_f32 v76, v76
  v_exp_f32 v77, v77
  v_smfmac_f32_32x32x32_bf16 v[92:107], v[24:27], v[68:75], v36
  v_exp_f32 v78, v78
  s_waitcnt lgkmcnt(0)
  v_mfma_f32_32x32x16_bf16 v[60:75], v[12:15], v[8:11], 0
  ds_read_b128 v[16:19], v37 offset:7168
  v_exp_f32 v79, v79
  v_exp_f32 v80, v80
  v_exp_f32 v81, v81
  v_exp_f32 v82, v82
  v_exp_f32 v83, v83
  s_waitcnt vmcnt(13)
  v_mfma_f32_32x32x16_bf16 v[108:123], v[140:143], v[148:151], v[108:123]
  buffer_load_dwordx4 v[140:143], v1, s[32:35], s24 offen offset:3072
  s_add_u32 s24, s24, 4096
  v_exp_f32 v84, v84
  v_exp_f32 v85, v85
  v_exp_f32 v86, v86
  v_exp_f32 v87, v87
  v_smfmac_f32_32x32x32_bf16 v[92:107], v[28:31], v[76:83], v36
  v_exp_f32 v88, v88
  v_exp_f32 v89, v89
  v_exp_f32 v90, v90
  s_waitcnt vmcnt(13)
  v_mfma_f32_32x32x16_bf16 v[124:139], v[144:147], v[148:151], v[124:139]
  buffer_load_dwordx4 v[148:151], v1, s[32:35], s26 offen offset:3072 sc1
  s_add_u32 s26, s26, 4096
  v_exp_f32 v91, v91
  v_exp_f32 v60, v60
  v_exp_f32 v61, v61
  v_smfmac_f32_32x32x32_bf16 v[92:107], v[32:35], v[84:91], v36
  s_mov_b64 exec, s[30:31]
  ds_read_b128 v[20:23], v3 offset:8192
  ds_read_b128 v[24:27], v3 offset:8704
  ds_read_b128 v[28:31], v3 offset:9216
  ds_read_b128 v[32:35], v3 offset:9728
  s_mov_b64 exec, -1
  v_exp_f32 v62, v62
  s_waitcnt lgkmcnt(4)
  v_mfma_f32_32x32x16_bf16 v[76:91], v[16:19], v[8:11], 0
  ds_read_b128 v[12:15], v37 offset:8192
  v_exp_f32 v63, v63
  v_exp_f32 v64, v64
  v_exp_f32 v65, v65
  v_exp_f32 v66, v66
  v_exp_f32 v67, v67
  s_waitcnt vmcnt(11)
  v_mfma_f32_32x32x16_bf16 v[108:123], v[44:47], v[52:55], v[108:123]
  buffer_load_dwordx4 v[144:147], v1, s[32:35], s25 offen offset:3072
  s_add_u32 s25, s25, 4096
  v_exp_f32 v68, v68
  v_exp_f32 v69, v69
  v_exp_f32 v70, v70
  v_exp_f32 v71, v71
  v_smfmac_f32_32x32x32_bf16 v[92:107], v[56:59], v[60:67], v36
  buffer_load_dwordx4 v[44:47], v1, s[32:35], s24 offen offset:0
  buffer_load_dwordx4 v[220:223], v1, s[32:35], s28 offen offset:3072
  s_add_u32 s28, s28, 4096
  v_exp_f32 v72, v72
  v_exp_f32 v73, v73
  v_exp_f32 v74, v74
  v_exp_f32 v75, v75
  v_exp_f32 v76, v76
  v_exp_f32 v77, v77
  v_smfmac_f32_32x32x32_bf16 v[92:107], v[248:251], v[68:75], v36
  v_exp_f32 v78, v78
  s_waitcnt lgkmcnt(0)
  v_mfma_f32_32x32x16_bf16 v[60:75], v[12:15], v[8:11], 0
  ds_read_b128 v[16:19], v37 offset:9216
  v_exp_f32 v79, v79
  v_exp_f32 v80, v80
  v_exp_f32 v81, v81
  v_exp_f32 v82, v82
  v_exp_f32 v83, v83
  s_waitcnt vmcnt(13)
  v_mfma_f32_32x32x16_bf16 v[124:139], v[48:51], v[52:55], v[124:139]
  buffer_load_dwordx4 v[52:55], v1, s[32:35], s26 offen offset:0 sc1
  v_exp_f32 v84, v84
  v_exp_f32 v85, v85
  v_exp_f32 v86, v86
  v_exp_f32 v87, v87
  v_smfmac_f32_32x32x32_bf16 v[92:107], v[20:23], v[76:83], v36
  buffer_load_dwordx4 v[48:51], v1, s[32:35], s25 offen offset:0
  v_exp_f32 v88, v88
  v_exp_f32 v89, v89
  v_exp_f32 v90, v90
  v_exp_f32 v91, v91
  v_exp_f32 v60, v60
  v_exp_f32 v61, v61
  v_smfmac_f32_32x32x32_bf16 v[92:107], v[24:27], v[84:91], v36
  s_mov_b64 exec, s[30:31]
  ds_read_b128 v[56:59], v3 offset:10240
  ds_read_b128 v[248:251], v3 offset:10752
  ds_read_b128 v[20:23], v3 offset:11264
  ds_read_b128 v[24:27], v3 offset:11776
  s_mov_b64 exec, -1
  v_exp_f32 v62, v62
  s_waitcnt lgkmcnt(4)
  v_mfma_f32_32x32x16_bf16 v[76:91], v[16:19], v[8:11], 0
  ds_read_b128 v[12:15], v37 offset:10240
  v_exp_f32 v63, v63
  v_exp_f32 v64, v64
  v_exp_f32 v65, v65
  v_exp_f32 v66, v66
  v_exp_f32 v67, v67
  s_waitcnt vmcnt(13)
  v_mfma_f32_32x32x16_bf16 v[108:123], v[152:155], v[160:163], v[108:123]
  buffer_load_dwordx4 v[152:155], v1, s[32:35], s24 offen offset:1024
  v_exp_f32 v68, v68
  v_exp_f32 v69, v69
  v_exp_f32 v70, v70
  v_exp_f32 v71, v71
  v_smfmac_f32_32x32x32_bf16 v[92:107], v[28:31], v[60:67], v36
  buffer_load_dwordx4 v[224:227], v1, s[32:35], s28 offen offset:0
  v_exp_f32 v72, v72
  v_exp_f32 v73, v73
  v_exp_f32 v74, v74
  v_exp_f32 v75, v75
  v_exp_f32 v76, v76
  v_exp_f32 v77, v77
  v_smfmac_f32_32x32x32_bf16 v[92:107], v[32:35], v[68:75], v36
  v_exp_f32 v78, v78
  s_waitcnt lgkmcnt(0)
  v_mfma_f32_32x32x16_bf16 v[60:75], v[12:15], v[8:11], 0
  ds_read_b128 v[16:19], v37 offset:11264
  v_exp_f32 v79, v79
  v_exp_f32 v80, v80
  v_exp_f32 v81, v81
  v_exp_f32 v82, v82
  v_exp_f32 v83, v83
  s_waitcnt vmcnt(14)
  v_mfma_f32_32x32x16_bf16 v[124:139], v[156:159], v[160:163], v[124:139]
  buffer_load_dwordx4 v[160:163], v1, s[32:35], s26 offen offset:1024 sc1
  v_exp_f32 v84, v84
  v_exp_f32 v85, v85
  v_exp_f32 v86, v86
  v_exp_f32 v87, v87
  v_smfmac_f32_32x32x32_bf16 v[92:107], v[56:59], v[76:83], v36
  buffer_load_dwordx4 v[156:159], v1, s[32:35], s25 offen offset:1024
  v_exp_f32 v88, v88
  v_exp_f32 v89, v89
  v_exp_f32 v90, v90
  v_exp_f32 v91, v91
  v_exp_f32 v60, v60
  v_exp_f32 v61, v61
  v_smfmac_f32_32x32x32_bf16 v[92:107], v[248:251], v[84:91], v36
  s_mov_b64 exec, s[30:31]
  ds_read_b128 v[28:31], v3 offset:12288
  ds_read_b128 v[32:35], v3 offset:12800
  ds_read_b128 v[56:59], v3 offset:13312
  ds_read_b128 v[248:251], v3 offset:13824
  s_mov_b64 exec, -1
  v_exp_f32 v62, v62
  s_waitcnt lgkmcnt(4)
  v_mfma_f32_32x32x16_bf16 v[76:91], v[16:19], v[8:11], 0
  ds_read_b128 v[12:15], v37 offset:12288
  v_exp_f32 v63, v63
  v_exp_f32 v64, v64
  v_exp_f32 v65, v65
  v_exp_f32 v66, v66
  v_exp_f32 v67, v67
  s_waitcnt vmcnt(13)
  v_mfma_f32_32x32x16_bf16 v[108:123], v[164:167], v[172:175], v[108:123]
  buffer_load_dwordx4 v[164:167], v1, s[32:35], s24 offen offset:2048
  v_exp_f32 v68, v68
  v_exp_f32 v69, v69
  v_exp_f32 v70, v70
  v_exp_f32 v71, v71
  v_smfmac_f32_32x32x32_bf16 v[92:107], v[20:23], v[60:67], v36
  buffer_load_dwordx4 v[228:231], v1, s[32:35], s28 offen offset:1024
  v_exp_f32 v72, v72
  v_exp_f32 v73, v73
  v_exp_f32 v74, v74
  s_waitcnt vmcnt(14)
  v_mfma_f32_32x32x16_bf16 v[124:139], v[168:171], v[172:175], v[124:139]
  buffer_load_dwordx4 v[172:175], v1, s[32:35], s26 offen offset:2048 sc1
  v_exp_f32 v75, v75
  s_setprio 2
  v_exp_f32 v76, v76
  v_exp_f32 v77, v77
  v_smfmac_f32_32x32x32_bf16 v[92:107], v[24:27], v[68:75], v36
  v_exp_f32 v78, v78
  s_waitcnt lgkmcnt(0)
  v_mfma_f32_32x32x16_bf16 v[60:75], v[12:15], v[8:11], 0
  ds_read_b128 v[16:19], v37 offset:13312
  v_exp_f32 v79, v79
  v_exp_f32 v80, v80
  v_exp_f32 v81, v81
  v_exp_f32 v82, v82
  v_exp_f32 v83, v83
  s_waitcnt vmcnt(12)
  v_mfma_f32_32x32x16_bf16 v[108:123], v[140:143], v[148:151], v[108:123]
  buffer_load_dwordx4 v[168:171], v1, s[32:35], s25 offen offset:2048
  v_exp_f32 v84, v84
  v_exp_f32 v85, v85
  v_exp_f32 v86, v86
  v_exp_f32 v87, v87
  v_smfmac_f32_32x32x32_bf16 v[92:107], v[28:31], v[76:83], v36
  buffer_load_dwordx4 v[140:143], v1, s[32:35], s24 offen offset:3072
  s_add_u32 s24, s24, 4096
  v_exp_f32 v88, v88
  v_exp_f32 v89, v89
  v_exp_f32 v90, v90
  v_exp_f32 v91, v91
  v_exp_f32 v60, v60
  v_exp_f32 v61, v61
  v_smfmac_f32_32x32x32_bf16 v[92:107], v[32:35], v[84:91], v36
  s_mov_b64 exec, s[30:31]
  ds_read_b128 v[20:23], v3 offset:14336
  ds_read_b128 v[24:27], v3 offset:14848
  ds_read_b128 v[28:31], v3 offset:15360
  ds_read_b128 v[32:35], v3 offset:15872
  s_mov_b64 exec, -1
  v_exp_f32 v62, v62
  s_waitcnt lgkmcnt(4)
  v_mfma_f32_32x32x16_bf16 v[76:91], v[16:19], v[8:11], 0
  ds_read_b128 v[12:15], v37 offset:14336
  v_exp_f32 v63, v63
  v_exp_f32 v64, v64
  v_exp_f32 v65, v65
  v_exp_f32 v66, v66
  v_exp_f32 v67, v67
  s_waitcnt vmcnt(13)
  v_mfma_f32_32x32x16_bf16 v[124:139], v[144:147], v[148:151], v[124:139]
  buffer_load_dwordx4 v[148:151], v1, s[32:35], s26 offen offset:3072 sc1
  s_add_u32 s26, s26, 4096
  v_exp_f32 v68, v68
  v_exp_f32 v69, v69
  v_exp_f32 v70, v70
  v_exp_f32 v71, v71
  v_smfmac_f32_32x32x32_bf16 v[92:107], v[56:59], v[60:67], v36
  buffer_load_dwordx4 v[144:147], v1, s[32:35], s25 offen offset:3072
  s_add_u32 s25, s25, 4096
  buffer_load_dwordx4 v[232:235], v1, s[32:35], s28 offen offset:2048
  v_exp_f32 v72, v72
  v_exp_f32 v73, v73
  v_exp_f32 v74, v74
  v_exp_f32 v75, v75
  v_exp_f32 v76, v76
  v_exp_f32 v77, v77
  v_smfmac_f32_32x32x32_bf16 v[92:107], v[248:251], v[68:75], v36
  v_exp_f32 v78, v78
  s_waitcnt lgkmcnt(0)
  v_mfma_f32_32x32x16_bf16 v[60:75], v[12:15], v[8:11], 0
  ds_read_b128 v[16:19], v37 offset:15360
  v_exp_f32 v79, v79
  v_exp_f32 v80, v80
  v_exp_f32 v81, v81
  v_exp_f32 v82, v82
  v_exp_f32 v83, v83
  s_waitcnt vmcnt(13)
  v_mfma_f32_32x32x16_bf16 v[108:123], v[44:47], v[52:55], v[108:123]
  buffer_load_dwordx4 v[44:47], v1, s[32:35], s24 offen offset:0
  v_exp_f32 v84, v84
  v_exp_f32 v85, v85
  v_exp_f32 v86, v86
  v_exp_f32 v87, v87
  v_smfmac_f32_32x32x32_bf16 v[92:107], v[20:23], v[76:83], v36
  v_exp_f32 v88, v88
  v_exp_f32 v89, v89
  v_exp_f32 v90, v90
  v_exp_f32 v91, v91
  v_exp_f32 v60, v60
  v_exp_f32 v61, v61
  v_smfmac_f32_32x32x32_bf16 v[92:107], v[24:27], v[84:91], v36
  s_mov_b64 exec, s[30:31]
  ds_read_b128 v[56:59], v3 offset:16384
  ds_read_b128 v[248:251], v3 offset:16896
  ds_read_b128 v[20:23], v3 offset:17408
  ds_read_b128 v[24:27], v3 offset:17920
  s_mov_b64 exec, -1
  v_exp_f32 v62, v62
  s_waitcnt lgkmcnt(4)
  v_mfma_f32_32x32x16_bf16 v[76:91], v[16:19], v[8:11], 0
  ds_read_b128 v[12:15], v37 offset:16384
  v_exp_f32 v63, v63
  v_exp_f32 v64, v64
  v_exp_f32 v65, v65
  v_exp_f32 v66, v66
  v_exp_f32 v67, v67
  s_waitcnt vmcnt(13)
  v_mfma_f32_32x32x16_bf16 v[124:139], v[48:51], v[52:55], v[124:139]
  buffer_load_dwordx4 v[52:55], v1, s[32:35], s26 offen offset:0 sc1
  v_exp_f32 v68, v68
  v_exp_f32 v69, v69
  v_exp_f32 v70, v70
  v_exp_f32 v71, v71
  v_smfmac_f32_32x32x32_bf16 v[92:107], v[28:31], v[60:67], v36
  buffer_load_dwordx4 v[48:51], v1, s[32:35], s25 offen offset:0
  buffer_load_dwordx4 v[236:239], v1, s[32:35], s28 offen offset:3072
  s_add_u32 s28, s28, 4096
  v_exp_f32 v72, v72
  v_exp_f32 v73, v73
  v_exp_f32 v74, v74
  v_exp_f32 v75, v75
  v_exp_f32 v76, v76
  v_exp_f32 v77, v77
  v_smfmac_f32_32x32x32_bf16 v[92:107], v[32:35], v[68:75], v36
  v_exp_f32 v78, v78
  s_waitcnt lgkmcnt(0)
  v_mfma_f32_32x32x16_bf16 v[60:75], v[12:15], v[8:11], 0
  ds_read_b128 v[16:19], v37 offset:17408
  v_exp_f32 v79, v79
  v_exp_f32 v80, v80
  v_exp_f32 v81, v81
  v_exp_f32 v82, v82
  v_exp_f32 v83, v83
  s_waitcnt vmcnt(13)
  v_mfma_f32_32x32x16_bf16 v[108:123], v[152:155], v[160:163], v[108:123]
  buffer_load_dwordx4 v[152:155], v1, s[32:35], s24 offen offset:1024
  v_exp_f32 v84, v84
  v_exp_f32 v85, v85
  v_exp_f32 v86, v86
  v_exp_f32 v87, v87
  v_smfmac_f32_32x32x32_bf16 v[92:107], v[56:59], v[76:83], v36
  v_exp_f32 v88, v88
  v_exp_f32 v89, v89
  v_exp_f32 v90, v90
  s_waitcnt vmcnt(13)
  v_mfma_f32_32x32x16_bf16 v[124:139], v[156:159], v[160:163], v[124:139]
  buffer_load_dwordx4 v[160:163], v1, s[32:35], s26 offen offset:1024 sc1
  v_exp_f32 v91, v91
  s_setprio 1
  v_exp_f32 v60, v60
  v_exp_f32 v61, v61
  v_smfmac_f32_32x32x32_bf16 v[92:107], v[248:251], v[84:91], v36
  s_mov_b64 exec, s[30:31]
  ds_read_b128 v[28:31], v3 offset:18432
  ds_read_b128 v[32:35], v3 offset:18944
  ds_read_b128 v[56:59], v3 offset:19456
  ds_read_b128 v[248:251], v3 offset:19968
  s_mov_b64 exec, -1
  v_exp_f32 v62, v62
  s_waitcnt lgkmcnt(4)
  v_mfma_f32_32x32x16_bf16 v[76:91], v[16:19], v[8:11], 0
  ds_read_b128 v[12:15], v37 offset:18432
  v_exp_f32 v63, v63
  v_exp_f32 v64, v64
  v_exp_f32 v65, v65
  v_exp_f32 v66, v66
  v_exp_f32 v67, v67
  s_waitcnt vmcnt(11)
  v_mfma_f32_32x32x16_bf16 v[108:123], v[164:167], v[172:175], v[108:123]
  buffer_load_dwordx4 v[156:159], v1, s[32:35], s25 offen offset:1024
  v_exp_f32 v68, v68
  v_exp_f32 v69, v69
  v_exp_f32 v70, v70
  v_exp_f32 v71, v71
  v_smfmac_f32_32x32x32_bf16 v[92:107], v[20:23], v[60:67], v36
  buffer_load_dwordx4 v[164:167], v1, s[32:35], s24 offen offset:2048
  v_exp_f32 v72, v72
  v_exp_f32 v73, v73
  v_exp_f32 v74, v74
  v_exp_f32 v75, v75
  v_exp_f32 v76, v76
  v_exp_f32 v77, v77
  v_smfmac_f32_32x32x32_bf16 v[92:107], v[24:27], v[68:75], v36
  v_exp_f32 v78, v78
  s_waitcnt lgkmcnt(0)
  v_mfma_f32_32x32x16_bf16 v[60:75], v[12:15], v[8:11], 0
  ds_read_b128 v[16:19], v37 offset:19456
  v_exp_f32 v79, v79
  v_exp_f32 v80, v80
  v_exp_f32 v81, v81
  v_exp_f32 v82, v82
  v_exp_f32 v83, v83
  s_waitcnt vmcnt(12)
  v_mfma_f32_32x32x16_bf16 v[124:139], v[168:171], v[172:175], v[124:139]
  buffer_load_dwordx4 v[172:175], v1, s[32:35], s26 offen offset:2048 sc1
  v_exp_f32 v84, v84
  v_exp_f32 v85, v85
  v_exp_f32 v86, v86
  v_exp_f32 v87, v87
  v_smfmac_f32_32x32x32_bf16 v[92:107], v[28:31], v[76:83], v36
  buffer_load_dwordx4 v[168:171], v1, s[32:35], s25 offen offset:2048
  v_exp_f32 v88, v88
  v_exp_f32 v89, v89
  v_exp_f32 v90, v90
  v_exp_f32 v91, v91
  s_setprio 0
  v_exp_f32 v60, v60
  v_exp_f32 v61, v61
  v_smfmac_f32_32x32x32_bf16 v[92:107], v[32:35], v[84:91], v36
  s_mov_b64 exec, s[30:31]
  ds_read_b128 v[20:23], v3 offset:20480
  ds_read_b128 v[24:27], v3 offset:20992
  s_mov_b64 exec, -1
  v_exp_f32 v62, v62
  s_waitcnt lgkmcnt(2)
  v_mfma_f32_32x32x16_bf16 v[76:91], v[16:19], v[8:11], 0
  v_exp_f32 v63, v63
  v_exp_f32 v64, v64
  v_exp_f32 v65, v65
  v_exp_f32 v66, v66
  v_exp_f32 v67, v67
  s_waitcnt vmcnt(12)
  v_mfma_f32_32x32x16_bf16 v[108:123], v[140:143], v[148:151], v[108:123]
  buffer_load_dwordx4 v[140:143], v1, s[32:35], s24 offen offset:3072
  s_add_u32 s24, s24, 4096
  v_exp_f32 v68, v68
  v_exp_f32 v69, v69
  v_exp_f32 v70, v70
  v_exp_f32 v71, v71
  v_smfmac_f32_32x32x32_bf16 v[92:107], v[56:59], v[60:67], v36
  v_exp_f32 v72, v72
  v_exp_f32 v73, v73
  v_exp_f32 v74, v74
  v_exp_f32 v75, v75
  v_exp_f32 v76, v76
  v_exp_f32 v77, v77
  v_smfmac_f32_32x32x32_bf16 v[92:107], v[248:251], v[68:75], v36
  v_exp_f32 v78, v78
  v_exp_f32 v79, v79
  v_exp_f32 v80, v80
  v_exp_f32 v81, v81
  v_exp_f32 v82, v82
  v_exp_f32 v83, v83
  s_waitcnt vmcnt(12)
  v_mfma_f32_32x32x16_bf16 v[124:139], v[144:147], v[148:151], v[124:139]
  buffer_load_dwordx4 v[148:151], v1, s[32:35], s26 offen offset:3072 sc1
  s_add_u32 s26, s26, 4096
  v_exp_f32 v84, v84
  v_exp_f32 v85, v85
  v_exp_f32 v86, v86
  v_exp_f32 v87, v87
  s_waitcnt lgkmcnt(1)
  v_smfmac_f32_32x32x32_bf16 v[92:107], v[20:23], v[76:83], v36
  buffer_load_dwordx4 v[144:147], v1, s[32:35], s25 offen offset:3072
  s_add_u32 s25, s25, 4096
  v_exp_f32 v88, v88
  v_exp_f32 v89, v89
  v_exp_f32 v90, v90
  v_exp_f32 v91, v91
  v_add_f32 v241, 1.0, v241
  s_nop 1
  s_waitcnt lgkmcnt(0)
  v_smfmac_f32_32x32x32_bf16 v[92:107], v[24:27], v[84:91], v36
  s_setprio 3
  v_rcp_f32 v241, v241
  s_waitcnt vmcnt(11)
  v_mfma_f32_32x32x16_bf16 v[108:123], v[44:47], v[52:55], v[108:123]
  s_nop 7
  v_add_f32 v5, abs(v92), abs(v93)
  v_add_f32 v6, abs(v94), abs(v95)
  v_add_f32 v5, v5, abs(v96)
  v_add_f32 v6, v6, abs(v97)
  v_add_f32 v5, v5, abs(v98)
  v_add_f32 v6, v6, abs(v99)
  v_add_f32 v5, v5, v6
  s_mov_b32 s15, 0x7f000000
  s_mov_b32 s16, 1736441856
  s_mov_b32 s17, 394264576
  v_cmp_nle_f32 vcc, v5, s15
  v_cmp_nle_f32 s[20:21], v100, s16
  v_cmp_nge_f32 s[22:23], v100, s17
  s_nop 0
  s_or_b64 vcc, vcc, s[20:21]
  s_or_b64 vcc, vcc, s[22:23]
  s_cbranch_vccnz L_slow

L_fin:
  v_rcp_f32 v5, v100
  s_lshl_b32 s15, s57, 15
  s_lshl_b32 s16, s56, 10
  s_add_u32 s15, s15, s16
  s_add_u32 s15, s15, 6291456
  v_mul_f32 v5, v5, v240

  v_mul_f32 v92, v92, v5
  v_mul_f32 v93, v93, v5
  v_mul_f32 v94, v94, v5
  v_mul_f32 v95, v95, v5
  v_mul_f32 v96, v96, v5
  v_mul_f32 v97, v97, v5
  v_mul_f32 v98, v98, v5
  v_mul_f32 v99, v99, v5
  v_cvt_pk_bf16_f32 v36, v92, v93
  v_cvt_pk_bf16_f32 v37, v94, v95
  v_cvt_pk_bf16_f32 v38, v96, v97
  v_cvt_pk_bf16_f32 v39, v98, v99
  buffer_store_dwordx4 v[36:39], v1, s[32:35], s15 offen sc1
  s_mov_b32 s95, 0

  s_lshl_b32 s26, s18, 15
  s_lshl_b32 s16, s27, 13
  s_add_u32 s26, s26, s16
  s_add_u32 s26, s26, 6291456
  s_add_u32 s24, s26, 4096

  s_barrier
  buffer_load_dwordx4 v[60:63], v1, s[32:35], s26 offen offset:0 sc1
  buffer_load_dwordx4 v[64:67], v1, s[32:35], s26 offen offset:1024 sc1
  buffer_load_dwordx4 v[68:71], v1, s[32:35], s26 offen offset:2048 sc1
  buffer_load_dwordx4 v[72:75], v1, s[32:35], s26 offen offset:3072 sc1
  buffer_load_dwordx4 v[76:79], v1, s[32:35], s24 offen offset:0 sc1
  buffer_load_dwordx4 v[80:83], v1, s[32:35], s24 offen offset:1024 sc1
  buffer_load_dwordx4 v[84:87], v1, s[32:35], s24 offen offset:2048 sc1
  buffer_load_dwordx4 v[88:91], v1, s[32:35], s24 offen offset:3072 sc1
  s_waitcnt vmcnt(19)
  v_mfma_f32_32x32x16_bf16 v[124:139], v[48:51], v[52:55], v[124:139]
  s_waitcnt vmcnt(16)
  v_mfma_f32_32x32x16_bf16 v[108:123], v[152:155], v[160:163], v[108:123]
  s_waitcnt vmcnt(15)
  v_mfma_f32_32x32x16_bf16 v[124:139], v[156:159], v[160:163], v[124:139]
  s_waitcnt vmcnt(13)
  v_mfma_f32_32x32x16_bf16 v[108:123], v[164:167], v[172:175], v[108:123]
  s_waitcnt vmcnt(12)
  v_mfma_f32_32x32x16_bf16 v[124:139], v[168:171], v[172:175], v[124:139]
  s_waitcnt vmcnt(10)
  v_mfma_f32_32x32x16_bf16 v[108:123], v[140:143], v[148:151], v[108:123]
  s_waitcnt vmcnt(9)
  v_mfma_f32_32x32x16_bf16 v[124:139], v[144:147], v[148:151], v[124:139]
  s_and_b32 s16, s12, 1
  s_mul_i32 s16, s16, 34816
  s_add_u32 s16, s16, 65536
  s_mul_i32 s17, s27, 8704
  s_add_u32 s17, s17, s16
  v_add_u32 v5, s17, v1
  s_lshl_b32 s17, s27, 7
  s_add_u32 s17, s17, s16
  v_and_b32 v7, 7, v2
  v_mul_u32_u24 v6, 1088, v7
  v_lshrrev_b32 v252, 3, v2
  v_lshl_add_u32 v6, v252, 4, v6
  v_add_u32 v6, s17, v6
  v_lshlrev_b32 v252, 10, v252
  v_lshl_add_u32 v252, v7, 4, v252
  s_lshl_b32 s15, s18, 15
  s_lshl_b32 s16, s48, 7
  s_add_u32 s15, s15, s16
  s_lshl_b32 s16, s27, 13
  s_add_u32 s15, s15, s16
  s_mov_b64 s[20:21], -1
  v_lshlrev_b32 v40, 10, v2
  v_add_u32 v40, 1020, v40

L_o0:
  s_waitcnt vmcnt(7)
  v_max3_u32 v7, v60, v61, v62
  v_max_u32 v7, v7, v63
  v_cmp_eq_u32 vcc, -1, v7
  s_nop 0
  s_and_b64 vcc, vcc, s[20:21]
  s_cbranch_vccnz L_ow0

L_om0:
  v_mfma_f32_32x32x16_bf16 v[108:123], v[176:179], v[60:63], v[108:123]
  v_mfma_f32_32x32x16_bf16 v[124:139], v[208:211], v[60:63], v[124:139]
L_o1:
  s_waitcnt vmcnt(6)
  v_max3_u32 v7, v64, v65, v66
  v_max_u32 v7, v7, v67
  v_cmp_eq_u32 vcc, -1, v7
  s_nop 0
  s_and_b64 vcc, vcc, s[20:21]
  s_cbranch_vccnz L_ow1

L_om1:
  v_mfma_f32_32x32x16_bf16 v[108:123], v[180:183], v[64:67], v[108:123]
  v_mfma_f32_32x32x16_bf16 v[124:139], v[212:215], v[64:67], v[124:139]
L_o2:
  s_waitcnt vmcnt(5)
  v_max3_u32 v7, v68, v69, v70
  v_max_u32 v7, v7, v71
  v_cmp_eq_u32 vcc, -1, v7
  s_nop 0
  s_and_b64 vcc, vcc, s[20:21]
  s_cbranch_vccnz L_ow2

L_om2:
  v_mfma_f32_32x32x16_bf16 v[108:123], v[184:187], v[68:71], v[108:123]
  v_mfma_f32_32x32x16_bf16 v[124:139], v[216:219], v[68:71], v[124:139]
L_o3:
  s_waitcnt vmcnt(4)
  v_max3_u32 v7, v72, v73, v74
  v_max_u32 v7, v7, v75
  v_cmp_eq_u32 vcc, -1, v7
  s_nop 0
  s_and_b64 vcc, vcc, s[20:21]
  s_cbranch_vccnz L_ow3

L_om3:
  v_mfma_f32_32x32x16_bf16 v[108:123], v[188:191], v[72:75], v[108:123]
  v_mfma_f32_32x32x16_bf16 v[124:139], v[220:223], v[72:75], v[124:139]
L_o4:
  s_waitcnt vmcnt(3)
  v_max3_u32 v7, v76, v77, v78
  v_max_u32 v7, v7, v79
  v_cmp_eq_u32 vcc, -1, v7
  s_nop 0
  s_and_b64 vcc, vcc, s[20:21]
  s_cbranch_vccnz L_ow4

L_om4:
  v_mfma_f32_32x32x16_bf16 v[108:123], v[192:195], v[76:79], v[108:123]
  v_mfma_f32_32x32x16_bf16 v[124:139], v[224:227], v[76:79], v[124:139]
L_o5:
  s_waitcnt vmcnt(2)
  v_max3_u32 v7, v80, v81, v82
  v_max_u32 v7, v7, v83
  v_cmp_eq_u32 vcc, -1, v7
  s_nop 0
  s_and_b64 vcc, vcc, s[20:21]
  s_cbranch_vccnz L_ow5

L_om5:
  v_mfma_f32_32x32x16_bf16 v[108:123], v[196:199], v[80:83], v[108:123]
  v_mfma_f32_32x32x16_bf16 v[124:139], v[228:231], v[80:83], v[124:139]
L_o6:
  s_waitcnt vmcnt(1)
  v_max3_u32 v7, v84, v85, v86
  v_max_u32 v7, v7, v87
  v_cmp_eq_u32 vcc, -1, v7
  s_nop 0
  s_and_b64 vcc, vcc, s[20:21]
  s_cbranch_vccnz L_ow6

L_om6:
  v_mfma_f32_32x32x16_bf16 v[108:123], v[200:203], v[84:87], v[108:123]
  v_mfma_f32_32x32x16_bf16 v[124:139], v[232:235], v[84:87], v[124:139]
L_o7:
  s_waitcnt vmcnt(0)
  v_max3_u32 v7, v88, v89, v90
  v_max_u32 v7, v7, v91
  v_cmp_eq_u32 vcc, -1, v7
  s_nop 0
  s_and_b64 vcc, vcc, s[20:21]
  s_cbranch_vccnz L_ow7

L_om7:
  v_mfma_f32_32x32x16_bf16 v[108:123], v[204:207], v[88:91], v[108:123]
  v_mfma_f32_32x32x16_bf16 v[124:139], v[236:239], v[88:91], v[124:139]
  s_nop 10
  ds_write_b128 v5, v[108:111] offset:0
  ds_write_b128 v5, v[112:115] offset:1088
  ds_write_b128 v5, v[116:119] offset:2176
  ds_write_b128 v5, v[120:123] offset:3264
  s_nop 0
  ds_write_b128 v5, v[124:127] offset:4352
  ds_write_b128 v5, v[128:131] offset:5440
  ds_write_b128 v5, v[132:135] offset:6528
  ds_write_b128 v5, v[136:139] offset:7616
  s_waitcnt lgkmcnt(0)
  s_barrier
  ds_read_b128 v[60:63], v6 offset:0
  ds_read_b128 v[64:67], v6 offset:8704
  ds_read_b128 v[68:71], v6 offset:17408
  ds_read_b128 v[72:75], v6 offset:26112
  ds_read_b128 v[76:79], v6 offset:512
  ds_read_b128 v[80:83], v6 offset:9216
  ds_read_b128 v[84:87], v6 offset:17920
  ds_read_b128 v[88:91], v6 offset:26624
  s_waitcnt lgkmcnt(4)
  v_add_f32 v60, v60, v64
  v_add_f32 v61, v61, v65
  v_add_f32 v62, v62, v66
  v_add_f32 v63, v63, v67
  v_add_f32 v68, v68, v72
  v_add_f32 v69, v69, v73
  v_add_f32 v70, v70, v74
  v_add_f32 v71, v71, v75
  v_add_f32 v60, v60, v68
  v_add_f32 v61, v61, v69
  v_add_f32 v62, v62, v70
  v_add_f32 v63, v63, v71
  v_mul_f32 v60, v60, v241
  v_mul_f32 v61, v61, v241
  v_mul_f32 v62, v62, v241
  v_mul_f32 v63, v63, v241
  s_waitcnt lgkmcnt(0)
  v_add_f32 v76, v76, v80
  v_add_f32 v77, v77, v81
  v_add_f32 v78, v78, v82
  v_add_f32 v79, v79, v83
  v_add_f32 v84, v84, v88
  v_add_f32 v85, v85, v89
  v_add_f32 v86, v86, v90
  v_add_f32 v87, v87, v91
  v_add_f32 v76, v76, v84
  v_add_f32 v77, v77, v85
  v_add_f32 v78, v78, v86
  v_add_f32 v79, v79, v87
  v_mul_f32 v76, v76, v241
  v_mul_f32 v77, v77, v241
  v_mul_f32 v78, v78, v241
  v_mul_f32 v79, v79, v241
  v_cvt_pk_bf16_f32 v36, v60, v61
  v_cvt_pk_bf16_f32 v37, v62, v63
  v_cvt_pk_bf16_f32 v38, v76, v77
  v_cvt_pk_bf16_f32 v39, v78, v79

  buffer_store_dwordx4 v[36:39], v252, s[68:71], s15 offen sc1

L_end:
  s_endpgm
L_ow0:
  s_waitcnt vmcnt(0)
  v_max_u32 v7, v64, v65
  v_max3_u32 v7, v7, v66, v67
  v_max3_u32 v7, v7, v68, v69
  v_max3_u32 v7, v7, v70, v71
  v_max3_u32 v7, v7, v72, v73
  v_max3_u32 v7, v7, v74, v75
  v_max3_u32 v7, v7, v76, v77
  v_max3_u32 v7, v7, v78, v79
  v_max3_u32 v7, v7, v80, v81
  v_max3_u32 v7, v7, v82, v83
  v_max3_u32 v7, v7, v84, v85
  v_max3_u32 v7, v7, v86, v87
  v_max3_u32 v7, v7, v88, v89
  v_max3_u32 v7, v7, v90, v91
  v_cmp_eq_u32 vcc, -1, v7
  s_nop 1
  s_cbranch_vccz L_of0

L_ol0:
  s_sleep 3
  s_mov_b64 exec, 255
  buffer_load_dword v7, v40, s[32:35], s26 offen sc1
  s_add_u32 s95, s95, 1
  s_cmp_gt_u32 s95, 5000
  s_cselect_b64 s[20:21], 0, -1
  s_waitcnt vmcnt(0)
  v_cmp_eq_u32 vcc, -1, v7
  s_mov_b64 exec, -1
  s_nop 0
  s_and_b32 s22, vcc_lo, s20
  s_bitcmp0_b32 s22, 0
  s_cbranch_scc1 L_or0
  s_cmp_lg_u32 s22, 1
  s_cbranch_scc1 L_ol0

L_or0:
  buffer_load_dwordx4 v[60:63], v1, s[32:35], s26 offen offset:0 sc1
  buffer_load_dwordx4 v[64:67], v1, s[32:35], s26 offen offset:1024 sc1
  buffer_load_dwordx4 v[68:71], v1, s[32:35], s26 offen offset:2048 sc1
  buffer_load_dwordx4 v[72:75], v1, s[32:35], s26 offen offset:3072 sc1
  buffer_load_dwordx4 v[76:79], v1, s[32:35], s24 offen offset:0 sc1
  buffer_load_dwordx4 v[80:83], v1, s[32:35], s24 offen offset:1024 sc1
  buffer_load_dwordx4 v[84:87], v1, s[32:35], s24 offen offset:2048 sc1
  buffer_load_dwordx4 v[88:91], v1, s[32:35], s24 offen offset:3072 sc1
  s_branch L_o0
L_of0:
  s_sleep 1
  buffer_load_dwordx4 v[60:63], v1, s[32:35], s26 offen offset:0 sc1
  s_add_u32 s95, s95, 1
  s_cmp_gt_u32 s95, 5000
  s_cselect_b64 s[20:21], 0, -1
  s_waitcnt vmcnt(0)
  s_branch L_o0

L_ow1:
  s_waitcnt vmcnt(0)
  v_max_u32 v7, v68, v69
  v_max3_u32 v7, v7, v70, v71
  v_max3_u32 v7, v7, v72, v73
  v_max3_u32 v7, v7, v74, v75
  v_max3_u32 v7, v7, v76, v77
  v_max3_u32 v7, v7, v78, v79
  v_max3_u32 v7, v7, v80, v81
  v_max3_u32 v7, v7, v82, v83
  v_max3_u32 v7, v7, v84, v85
  v_max3_u32 v7, v7, v86, v87
  v_max3_u32 v7, v7, v88, v89
  v_max3_u32 v7, v7, v90, v91
  v_cmp_eq_u32 vcc, -1, v7
  s_nop 1
  s_cbranch_vccz L_of1

L_ol1:
  s_sleep 3
  s_mov_b64 exec, 254
  buffer_load_dword v7, v40, s[32:35], s26 offen sc1
  s_add_u32 s95, s95, 1
  s_cmp_gt_u32 s95, 5000
  s_cselect_b64 s[20:21], 0, -1
  s_waitcnt vmcnt(0)
  v_cmp_eq_u32 vcc, -1, v7
  s_mov_b64 exec, -1
  s_nop 0
  s_and_b32 s22, vcc_lo, s20
  s_bitcmp0_b32 s22, 1
  s_cbranch_scc1 L_or1
  s_cmp_lg_u32 s22, 2
  s_cbranch_scc1 L_ol1

L_or1:
  buffer_load_dwordx4 v[64:67], v1, s[32:35], s26 offen offset:1024 sc1
  buffer_load_dwordx4 v[68:71], v1, s[32:35], s26 offen offset:2048 sc1
  buffer_load_dwordx4 v[72:75], v1, s[32:35], s26 offen offset:3072 sc1
  buffer_load_dwordx4 v[76:79], v1, s[32:35], s24 offen offset:0 sc1
  buffer_load_dwordx4 v[80:83], v1, s[32:35], s24 offen offset:1024 sc1
  buffer_load_dwordx4 v[84:87], v1, s[32:35], s24 offen offset:2048 sc1
  buffer_load_dwordx4 v[88:91], v1, s[32:35], s24 offen offset:3072 sc1
  s_branch L_o1
L_of1:
  s_sleep 1
  buffer_load_dwordx4 v[64:67], v1, s[32:35], s26 offen offset:1024 sc1
  s_add_u32 s95, s95, 1
  s_cmp_gt_u32 s95, 5000
  s_cselect_b64 s[20:21], 0, -1
  s_waitcnt vmcnt(0)
  s_branch L_o1

L_ow2:
  s_waitcnt vmcnt(0)
  v_max_u32 v7, v72, v73
  v_max3_u32 v7, v7, v74, v75
  v_max3_u32 v7, v7, v76, v77
  v_max3_u32 v7, v7, v78, v79
  v_max3_u32 v7, v7, v80, v81
  v_max3_u32 v7, v7, v82, v83
  v_max3_u32 v7, v7, v84, v85
  v_max3_u32 v7, v7, v86, v87
  v_max3_u32 v7, v7, v88, v89
  v_max3_u32 v7, v7, v90, v91
  v_cmp_eq_u32 vcc, -1, v7
  s_nop 1
  s_cbranch_vccz L_of2

L_ol2:
  s_sleep 3
  s_mov_b64 exec, 252
  buffer_load_dword v7, v40, s[32:35], s26 offen sc1
  s_add_u32 s95, s95, 1
  s_cmp_gt_u32 s95, 5000
  s_cselect_b64 s[20:21], 0, -1
  s_waitcnt vmcnt(0)
  v_cmp_eq_u32 vcc, -1, v7
  s_mov_b64 exec, -1
  s_nop 0
  s_and_b32 s22, vcc_lo, s20
  s_bitcmp0_b32 s22, 2
  s_cbranch_scc1 L_or2
  s_cmp_lg_u32 s22, 4
  s_cbranch_scc1 L_ol2

L_or2:
  buffer_load_dwordx4 v[68:71], v1, s[32:35], s26 offen offset:2048 sc1
  buffer_load_dwordx4 v[72:75], v1, s[32:35], s26 offen offset:3072 sc1
  buffer_load_dwordx4 v[76:79], v1, s[32:35], s24 offen offset:0 sc1
  buffer_load_dwordx4 v[80:83], v1, s[32:35], s24 offen offset:1024 sc1
  buffer_load_dwordx4 v[84:87], v1, s[32:35], s24 offen offset:2048 sc1
  buffer_load_dwordx4 v[88:91], v1, s[32:35], s24 offen offset:3072 sc1
  s_branch L_o2
L_of2:
  s_sleep 1
  buffer_load_dwordx4 v[68:71], v1, s[32:35], s26 offen offset:2048 sc1
  s_add_u32 s95, s95, 1
  s_cmp_gt_u32 s95, 5000
  s_cselect_b64 s[20:21], 0, -1
  s_waitcnt vmcnt(0)
  s_branch L_o2

L_ow3:
  s_waitcnt vmcnt(0)
  v_max_u32 v7, v76, v77
  v_max3_u32 v7, v7, v78, v79
  v_max3_u32 v7, v7, v80, v81
  v_max3_u32 v7, v7, v82, v83
  v_max3_u32 v7, v7, v84, v85
  v_max3_u32 v7, v7, v86, v87
  v_max3_u32 v7, v7, v88, v89
  v_max3_u32 v7, v7, v90, v91
  v_cmp_eq_u32 vcc, -1, v7
  s_nop 1
  s_cbranch_vccz L_of3

L_ol3:
  s_sleep 3
  s_mov_b64 exec, 248
  buffer_load_dword v7, v40, s[32:35], s26 offen sc1
  s_add_u32 s95, s95, 1
  s_cmp_gt_u32 s95, 5000
  s_cselect_b64 s[20:21], 0, -1
  s_waitcnt vmcnt(0)
  v_cmp_eq_u32 vcc, -1, v7
  s_mov_b64 exec, -1
  s_nop 0
  s_and_b32 s22, vcc_lo, s20
  s_bitcmp0_b32 s22, 3
  s_cbranch_scc1 L_or3
  s_cmp_lg_u32 s22, 8
  s_cbranch_scc1 L_ol3

L_or3:
  buffer_load_dwordx4 v[72:75], v1, s[32:35], s26 offen offset:3072 sc1
  buffer_load_dwordx4 v[76:79], v1, s[32:35], s24 offen offset:0 sc1
  buffer_load_dwordx4 v[80:83], v1, s[32:35], s24 offen offset:1024 sc1
  buffer_load_dwordx4 v[84:87], v1, s[32:35], s24 offen offset:2048 sc1
  buffer_load_dwordx4 v[88:91], v1, s[32:35], s24 offen offset:3072 sc1
  s_branch L_o3
L_of3:
  s_sleep 1
  buffer_load_dwordx4 v[72:75], v1, s[32:35], s26 offen offset:3072 sc1
  s_add_u32 s95, s95, 1
  s_cmp_gt_u32 s95, 5000
  s_cselect_b64 s[20:21], 0, -1
  s_waitcnt vmcnt(0)
  s_branch L_o3

L_ow4:
  s_waitcnt vmcnt(0)
  v_max_u32 v7, v80, v81
  v_max3_u32 v7, v7, v82, v83
  v_max3_u32 v7, v7, v84, v85
  v_max3_u32 v7, v7, v86, v87
  v_max3_u32 v7, v7, v88, v89
  v_max3_u32 v7, v7, v90, v91
  v_cmp_eq_u32 vcc, -1, v7
  s_nop 1
  s_cbranch_vccz L_of4

L_ol4:
  s_sleep 3
  s_mov_b64 exec, 240
  buffer_load_dword v7, v40, s[32:35], s26 offen sc1
  s_add_u32 s95, s95, 1
  s_cmp_gt_u32 s95, 5000
  s_cselect_b64 s[20:21], 0, -1
  s_waitcnt vmcnt(0)
  v_cmp_eq_u32 vcc, -1, v7
  s_mov_b64 exec, -1
  s_nop 0
  s_and_b32 s22, vcc_lo, s20
  s_bitcmp0_b32 s22, 4
  s_cbranch_scc1 L_or4
  s_cmp_lg_u32 s22, 16
  s_cbranch_scc1 L_ol4

L_or4:
  buffer_load_dwordx4 v[76:79], v1, s[32:35], s24 offen offset:0 sc1
  buffer_load_dwordx4 v[80:83], v1, s[32:35], s24 offen offset:1024 sc1
  buffer_load_dwordx4 v[84:87], v1, s[32:35], s24 offen offset:2048 sc1
  buffer_load_dwordx4 v[88:91], v1, s[32:35], s24 offen offset:3072 sc1
  s_branch L_o4
L_of4:
  s_sleep 1
  buffer_load_dwordx4 v[76:79], v1, s[32:35], s24 offen offset:0 sc1
  s_add_u32 s95, s95, 1
  s_cmp_gt_u32 s95, 5000
  s_cselect_b64 s[20:21], 0, -1
  s_waitcnt vmcnt(0)
  s_branch L_o4

L_ow5:
  s_waitcnt vmcnt(0)
  v_max_u32 v7, v84, v85
  v_max3_u32 v7, v7, v86, v87
  v_max3_u32 v7, v7, v88, v89
  v_max3_u32 v7, v7, v90, v91
  v_cmp_eq_u32 vcc, -1, v7
  s_nop 1
  s_cbranch_vccz L_of5

L_ol5:
  s_sleep 3
  s_mov_b64 exec, 224
  buffer_load_dword v7, v40, s[32:35], s26 offen sc1
  s_add_u32 s95, s95, 1
  s_cmp_gt_u32 s95, 5000
  s_cselect_b64 s[20:21], 0, -1
  s_waitcnt vmcnt(0)
  v_cmp_eq_u32 vcc, -1, v7
  s_mov_b64 exec, -1
  s_nop 0
  s_and_b32 s22, vcc_lo, s20
  s_bitcmp0_b32 s22, 5
  s_cbranch_scc1 L_or5
  s_cmp_lg_u32 s22, 32
  s_cbranch_scc1 L_ol5

L_or5:
  buffer_load_dwordx4 v[80:83], v1, s[32:35], s24 offen offset:1024 sc1
  buffer_load_dwordx4 v[84:87], v1, s[32:35], s24 offen offset:2048 sc1
  buffer_load_dwordx4 v[88:91], v1, s[32:35], s24 offen offset:3072 sc1
  s_branch L_o5
L_of5:
  s_sleep 1
  buffer_load_dwordx4 v[80:83], v1, s[32:35], s24 offen offset:1024 sc1
  s_add_u32 s95, s95, 1
  s_cmp_gt_u32 s95, 5000
  s_cselect_b64 s[20:21], 0, -1
  s_waitcnt vmcnt(0)
  s_branch L_o5

L_ow6:
  s_waitcnt vmcnt(0)
  v_max_u32 v7, v88, v89
  v_max3_u32 v7, v7, v90, v91
  v_cmp_eq_u32 vcc, -1, v7
  s_nop 1
  s_cbranch_vccz L_of6

L_ol6:
  s_sleep 3
  s_mov_b64 exec, 192
  buffer_load_dword v7, v40, s[32:35], s26 offen sc1
  s_add_u32 s95, s95, 1
  s_cmp_gt_u32 s95, 5000
  s_cselect_b64 s[20:21], 0, -1
  s_waitcnt vmcnt(0)
  v_cmp_eq_u32 vcc, -1, v7
  s_mov_b64 exec, -1
  s_nop 0
  s_and_b32 s22, vcc_lo, s20
  s_bitcmp0_b32 s22, 6
  s_cbranch_scc1 L_or6
  s_cmp_lg_u32 s22, 64
  s_cbranch_scc1 L_ol6

L_or6:
  buffer_load_dwordx4 v[84:87], v1, s[32:35], s24 offen offset:2048 sc1
  buffer_load_dwordx4 v[88:91], v1, s[32:35], s24 offen offset:3072 sc1
  s_branch L_o6
L_of6:
  s_sleep 1
  buffer_load_dwordx4 v[84:87], v1, s[32:35], s24 offen offset:2048 sc1
  s_add_u32 s95, s95, 1
  s_cmp_gt_u32 s95, 5000
  s_cselect_b64 s[20:21], 0, -1
  s_waitcnt vmcnt(0)
  s_branch L_o6

L_ow7:
  s_waitcnt vmcnt(0)
  s_sleep 1
  buffer_load_dwordx4 v[88:91], v1, s[32:35], s24 offen offset:3072 sc1
  s_add_u32 s95, s95, 1
  s_cmp_gt_u32 s95, 5000
  s_cselect_b64 s[20:21], 0, -1
  s_waitcnt vmcnt(0)
  s_branch L_o7

L_wc15:
  s_mov_b32 s95, 0
L_ws16:
  ds_read_b64 v[20:21], v23 offset:0
  s_add_u32 s95, s95, 1
  s_waitcnt lgkmcnt(0)
  v_cmp_ne_u64 vcc, s[72:73], v[20:21]
  s_cmp_gt_u32 s95, 320000
  s_cbranch_scc1 L_wd16

  s_cbranch_vccz L_wd16
  s_sleep 1
  s_branch L_ws16
L_wd16:
  s_branch L_wr15
L_wc18:
  s_mov_b32 s95, 0
L_ws19:
  ds_read_b64 v[20:21], v23 offset:0
  s_add_u32 s95, s95, 1
  s_waitcnt lgkmcnt(0)
  v_cmp_ne_u64 vcc, s[72:73], v[20:21]
  s_cmp_gt_u32 s95, 320000
  s_cbranch_scc1 L_wd19

  s_cbranch_vccz L_wd19
  s_sleep 1
  s_branch L_ws19
L_wd19:
  s_branch L_wr18
L_wc21:
  s_mov_b32 s95, 0
L_ws22:
  ds_read_b64 v[202:203], v0 offset:128
  s_add_u32 s95, s95, 1
  s_waitcnt lgkmcnt(0)
  v_cmp_ne_u64 vcc, s[72:73], v[202:203]
  s_cmp_gt_u32 s95, 320000
  s_cbranch_scc1 L_wd22

  s_cbranch_vccz L_wd22
  s_sleep 1
  s_branch L_ws22
L_wd22:
  s_branch L_wr21
L_wc23:
  s_mov_b32 s95, 0
L_ws24:
  ds_read_b64 v[202:203], v0 offset:160
  s_add_u32 s95, s95, 1
  s_waitcnt lgkmcnt(0)
  v_cmp_ne_u64 vcc, s[72:73], v[202:203]
  s_cmp_gt_u32 s95, 320000
  s_cbranch_scc1 L_wd24

  s_cbranch_vccz L_wd24
  s_sleep 1
  s_branch L_ws24
L_wd24:
  s_branch L_wr23
L_wc27:
  s_mov_b32 s95, 0
L_ws28:
  ds_read_b64 v[62:63], v0 offset:64
  s_add_u32 s95, s95, 1
  s_waitcnt lgkmcnt(0)
  v_cmp_ne_u64 vcc, s[72:73], v[62:63]
  s_cmp_gt_u32 s95, 320000
  s_cbranch_scc1 L_wd28

  s_cbranch_vccz L_wd28
  s_sleep 1
  s_branch L_ws28
L_wd28:
  s_branch L_wr27
L_jl:
  ds_read_b64_tr_b16 v[108:109], v17 offset:0
  ds_read_b64_tr_b16 v[110:111], v17 offset:2048
  ds_read_b64_tr_b16 v[112:113], v17 offset:64
  ds_read_b64_tr_b16 v[114:115], v17 offset:2112
  ds_read_b64_tr_b16 v[116:117], v17 offset:128
  ds_read_b64_tr_b16 v[118:119], v17 offset:2176
  ds_read_b64_tr_b16 v[120:121], v17 offset:192
  ds_read_b64_tr_b16 v[122:123], v17 offset:2240
  s_waitcnt lgkmcnt(0)
  ds_read_b64_tr_b16 v[128:129], v17 offset:16384
  ds_read_b64_tr_b16 v[130:131], v17 offset:18432
  ds_read_b64_tr_b16 v[132:133], v17 offset:16448
  ds_read_b64_tr_b16 v[134:135], v17 offset:18496
  ds_read_b64_tr_b16 v[136:137], v17 offset:16512
  ds_read_b64_tr_b16 v[138:139], v17 offset:18560
  ds_read_b64_tr_b16 v[140:141], v17 offset:16576
  ds_read_b64_tr_b16 v[142:143], v17 offset:18624
  s_waitcnt lgkmcnt(0)
  s_branch L_jlr
L_fc30:
  s_waitcnt vmcnt(0)
  s_mov_b64 exec, 1
  buffer_store_dwordx2 v[242:243], v244, s[32:35], s49 offen sc1
  s_mov_b64 exec, -1
  s_mov_b32 s11, 1
  s_branch L_fcr30
L_wc31:
  s_mov_b32 s95, 0
L_ws32:
  ds_read_b64 v[204:205], v0 offset:192
  s_add_u32 s95, s95, 1
  s_waitcnt lgkmcnt(0)
  v_cmp_ne_u64 vcc, s[72:73], v[204:205]
  s_cmp_gt_u32 s95, 320000
  s_cbranch_scc1 L_wd32

  s_cbranch_vccz L_wd32
  s_sleep 1
  s_branch L_ws32
L_wd32:
  s_branch L_wr31
L_wc33:
  s_mov_b32 s95, 0
L_ws34:
  ds_read_b64 v[202:203], v0 offset:160
  s_add_u32 s95, s95, 1
  s_waitcnt lgkmcnt(0)
  v_cmp_ne_u64 vcc, s[72:73], v[202:203]
  s_cmp_gt_u32 s95, 320000
  s_cbranch_scc1 L_wd34

  s_cbranch_vccz L_wd34
  s_sleep 1
  s_branch L_ws34
L_wd34:
  s_branch L_wr33
L_pslow:
  s_mov_b32 s95, 0
  s_mov_b64 exec, s[4:5]
L_poll35:
  buffer_load_dwordx2 v[246:247], v252, s[32:35], s16 offen sc1
  s_add_u32 s95, s95, 1
  s_waitcnt vmcnt(0)
  v_cmp_ne_u64 vcc, s[72:73], v[246:247]
  s_nop 1
  s_cmp_gt_u32 s95, 20000
  s_cbranch_scc1 L_polld35
  s_cbranch_vccz L_polld35
  s_sleep 8
  s_branch L_poll35
L_polld35:
  s_mov_b64 exec, -1
  s_branch L_pok
L_slow:
  s_mov_b32 s15, 0xff800000
  v_mov_b32 v7, s15
  v_mov_b32 v4, v1
  v_add_u32 v3, 45056, v3
  v_mov_b32 v92, 0
  v_mov_b32 v93, 0
  v_mov_b32 v94, 0
  v_mov_b32 v95, 0
  v_mov_b32 v96, 0
  v_mov_b32 v97, 0
  v_mov_b32 v98, 0
  v_mov_b32 v99, 0
  v_mov_b32 v100, 0
  v_mov_b32 v101, 0
  v_mov_b32 v102, 0
  v_mov_b32 v103, 0
  v_mov_b32 v104, 0
  v_mov_b32 v105, 0
  v_mov_b32 v106, 0
  v_mov_b32 v107, 0
  s_mov_b32 s22, 0
L_slowloop:
  buffer_load_dwordx4 v[12:15], v4, s[32:35], s58 offen sc1
  s_mov_b64 exec, s[30:31]
  buffer_load_dwordx4 v[20:23], v3, s[32:35], s58 offen sc1
  buffer_load_dwordx4 v[24:27], v3, s[32:35], s58 offen offset:512 sc1
  s_mov_b64 exec, -1
  s_waitcnt vmcnt(0)
  v_mfma_f32_32x32x16_bf16 v[60:75], v[12:15], v[8:11], 0
  v_add_u32 v4, 1024, v4
  v_add_u32 v3, 1024, v3
  s_nop 9
  v_max3_f32 v5, v60, v61, v62
  v_max3_f32 v5, v5, v63, v64
  v_max3_f32 v5, v5, v65, v66
  v_max3_f32 v5, v5, v67, v68
  v_max3_f32 v5, v5, v69, v70
  v_max3_f32 v5, v5, v71, v72
  v_max3_f32 v5, v5, v73, v74
  v_max_f32 v5, v5, v75
  v_mov_b32 v6, v5
  s_nop 1
  v_permlane32_swap_b32 v5, v6
  s_nop 1
  v_max3_f32 v5, v5, v6, v7
  v_sub_f32 v6, v7, v5
  v_exp_f32 v6, v6
  v_mov_b32 v7, v5

  v_mul_f32 v92, v92, v6
  v_mul_f32 v93, v93, v6
  v_mul_f32 v94, v94, v6
  v_mul_f32 v95, v95, v6
  v_mul_f32 v96, v96, v6
  v_mul_f32 v97, v97, v6
  v_mul_f32 v98, v98, v6
  v_mul_f32 v99, v99, v6
  v_mul_f32 v100, v100, v6
  v_mul_f32 v101, v101, v6
  v_mul_f32 v102, v102, v6
  v_mul_f32 v103, v103, v6
  v_mul_f32 v104, v104, v6
  v_mul_f32 v105, v105, v6
  v_mul_f32 v106, v106, v6
  v_mul_f32 v107, v107, v6
  v_sub_f32 v60, v60, v7
  v_sub_f32 v61, v61, v7
  v_sub_f32 v62, v62, v7
  v_sub_f32 v63, v63, v7
  v_sub_f32 v64, v64, v7
  v_sub_f32 v65, v65, v7
  v_sub_f32 v66, v66, v7
  v_sub_f32 v67, v67, v7
  v_sub_f32 v68, v68, v7
  v_sub_f32 v69, v69, v7
  v_sub_f32 v70, v70, v7
  v_sub_f32 v71, v71, v7
  v_sub_f32 v72, v72, v7
  v_sub_f32 v73, v73, v7
  v_sub_f32 v74, v74, v7
  v_sub_f32 v75, v75, v7
  v_exp_f32 v60, v60
  v_exp_f32 v61, v61
  v_exp_f32 v62, v62
  v_exp_f32 v63, v63
  v_exp_f32 v64, v64
  v_exp_f32 v65, v65
  v_exp_f32 v66, v66
  v_exp_f32 v67, v67
  v_exp_f32 v68, v68
  v_exp_f32 v69, v69
  v_exp_f32 v70, v70
  v_exp_f32 v71, v71
  v_exp_f32 v72, v72
  v_exp_f32 v73, v73
  v_exp_f32 v74, v74
  v_exp_f32 v75, v75
  s_nop 0
  v_cvt_pk_bf16_f32 v36, v60, v61
  v_cvt_pk_bf16_f32 v37, v62, v63
  v_cvt_pk_bf16_f32 v38, v64, v65
  v_cvt_pk_bf16_f32 v39, v66, v67
  v_cvt_pk_bf16_f32 v40, v68, v69
  v_cvt_pk_bf16_f32 v41, v70, v71
  v_cvt_pk_bf16_f32 v42, v72, v73
  v_cvt_pk_bf16_f32 v43, v74, v75
  s_nop 1
  v_mfma_f32_32x32x16_bf16 v[92:107], v[20:23], v[36:39], v[92:107]
  v_mfma_f32_32x32x16_bf16 v[92:107], v[24:27], v[40:43], v[92:107]
  s_add_u32 s22, s22, 1
  s_cmp_lt_u32 s22, 64
  s_nop 11
  s_cbranch_scc1 L_slowloop

  s_branch L_fin
L_codeend:
.section .rodata,"a"
.p2align 6
.amdhsa_kernel gated_mix__softmax_full_mha__dense_activation_silu__prompt_kernel
  .amdhsa_next_free_vgpr 256
  .amdhsa_next_free_sgpr 102
  .amdhsa_accum_offset 256
  .amdhsa_group_segment_fixed_size 0
  .amdhsa_kernarg_size 80
  .amdhsa_user_sgpr_count 2
  .amdhsa_user_sgpr_kernarg_segment_ptr 1
  .amdhsa_system_sgpr_workgroup_id_x 1
.end_amdhsa_kernel
.text
```
